```python
import torch

def _softmax(x, axis=-1):
    return torch.softmax(x, dim=axis)

def _gelu(x):
    return torch.nn.functional.gelu(x, approximate='tanh')

def _silu(x):
    return torch.nn.functional.silu(x)

def _sigmoid(x):
    return torch.sigmoid(x)

def _layernorm(x, axis=-1, eps=1e-05):
    m = x.mean(dim=axis, keepdim=True)
    v = x.var(dim=axis, keepdim=True, unbiased=False)
    return (x - m) / torch.sqrt(v + eps)

def _scatter_add(tgt, idx, src, axis=0):
    return tgt.clone().index_add_(axis, idx, src)

def _segment_sum(src, seg, n):
    out = torch.zeros((n,) + src.shape[1:], dtype=src.dtype)
    return out.index_add_(0, seg, src)

def _pad(x, pw):
    flat = tuple((v for pair in reversed(pw) for v in pair))
    return torch.nn.functional.pad(x, flat)
kernel_name = 'standalone__conformer_family_branchformer__speech'

def setup_inputs():

    _w = lambda a: (lambda t: t.to(torch.bfloat16) if t.is_floating_point() else t)(torch.as_tensor(a))
    B, T, D, K = (2, 1000, 512, 31)
    s = float(D) ** (-0.5)
    return {'x': _w((lambda *s: torch.randn(*s, dtype=torch.bfloat16) * 0.05)(B, T, D)), 'w_q': _w((lambda *s: torch.randn(*s, dtype=torch.bfloat16) * 1.6)(D, D) * s), 'w_k': _w((lambda *s: torch.randn(*s, dtype=torch.bfloat16) * 1.6)(D, D) * s), 'w_v': _w((lambda *s: torch.randn(*s, dtype=torch.bfloat16) * 0.8)(D, D) * s), 'w_ao': _w((lambda *s: torch.randn(*s, dtype=torch.bfloat16) * 0.8)(D, D) * s), 'w_up': _w((lambda *s: torch.randn(*s, dtype=torch.bfloat16) * 1.6)(D, 2 * D) * s), 'dw': _w((lambda *s: torch.randn(*s, dtype=torch.bfloat16) * 1.6)(K, D) * (1.0 / K)), 'w_dn': _w((lambda *s: torch.randn(*s, dtype=torch.bfloat16) * 0.8)(D, D) * s), 'w_merge': _w((lambda *s: torch.randn(*s, dtype=torch.bfloat16) * 0.8)(2 * D, D) * s)}

def reference(x, w_q, w_k, w_v, w_ao, w_up, dw, w_dn, w_merge):
    B, T, D = x.shape
    K = dw.shape[0]
    xa = _layernorm(x, axis=-1)
    q = torch.einsum('btd,de->bte', xa, w_q)
    k = torch.einsum('btd,de->bte', xa, w_k)
    v = torch.einsum('btd,de->bte', xa, w_v)
    logits = torch.einsum('btd,bsd->bts', q, k) * float(D) ** (-0.5)
    attn = _softmax(logits, axis=-1)
    ya = torch.einsum('bts,bsd->btd', attn, v)
    ya = torch.einsum('btd,de->bte', ya, w_ao)
    xc = _layernorm(x, axis=-1)
    h = _gelu(torch.einsum('btd,de->bte', xc, w_up))
    u = h[..., :D].clone()
    g = _layernorm(h[..., D:], axis=-1)
    pad = K // 2
    gp = _pad(g, ((0, 0), (pad, pad), (0, 0)))
    conv = torch.zeros_like(g)
    for i in range(K):
        conv = conv + gp[:, i:i + T, :] * dw[i][None, None, :]
    yc = torch.einsum('btd,de->bte', u * conv, w_dn)
    merged = torch.concatenate([ya, yc], axis=-1)
    out = torch.einsum('btf,fd->btd', merged, w_merge)
    return x + out
```

```asm
; @launch kernel=k1_kernel grid=(256,1,1) block=(512,1,1) lds=122880
; @launch kernel=k2_kernel grid=(256,1,1) block=(512,1,1) lds=131072
; @launch kernel=k3_kernel grid=(256,1,1) block=(256,1,1) lds=106496
.amdgcn_target "amdgcn-amd-amdhsa--gfx950"
.text
.globl k1_kernel
.p2align 8
.type k1_kernel,@function
k1_kernel:
    s_cmp_ge_u32 s2, 256
    s_cbranch_scc1 K1_IDLE
    s_cmp_lt_u32 s2, 240
    s_cbranch_scc1 K1_GO
    s_and_b32 s20, s2, 7
    s_cmp_lt_u32 s20, 4
    s_cbranch_scc1 K1_GO
    s_cmp_lg_u32 s2, 244
    s_cbranch_scc1 K1_IDLE
    s_load_dwordx2 s[4:5], s[0:1], 48
    v_lshlrev_b32 v1, 7, v0
    s_waitcnt lgkmcnt(0)
    s_mov_b32 s8, s4
    s_mov_b32 s9, s5
    s_mov_b32 s10, 31744
    s_mov_b32 s11, 131072
    buffer_load_dword v2, v1, s[8:11], 0 offen
K1_IDLE:
    s_branch K1_END
K1_GO:
    s_load_dwordx16 s[4:19], s[0:1], 0
    s_load_dwordx2 s[100:101], s[0:1], 64
    s_load_dwordx2 s[98:99], s[0:1], 88
    v_lshrrev_b32 v152, 6, v0
    v_and_b32 v151, 63, v0
    v_readfirstlane_b32 s44, v152
    s_and_b32 s20, s2, 7
    s_lshr_b32 s21, s2, 3
    s_cmp_ge_u32 s21, 24
    s_cselect_b32 s49, 1, 0
    s_cmp_ge_u32 s20, 4
    s_cselect_b32 s49, s49, 0
    s_lshr_b32 s45, s44, 2
    s_and_b32 s46, s44, 3
    s_lshl_b32 s57, s44, 10
    s_cmp_eq_u32 s49, 1
    s_cbranch_scc1 K1F_1
    s_and_b32 s47, s20, 3
    s_lshl_b32 s47, s47, 2
    s_and_b32 s22, s21, 3
    s_add_u32 s47, s47, s22
    s_lshr_b32 s48, s20, 2
    s_lshl_b32 s48, s48, 3
    s_lshr_b32 s22, s21, 2
    s_add_u32 s48, s48, s22
    s_lshl_b32 s61, s48, 1
    s_cmp_ge_u32 s48, 12
    s_cselect_b32 s61, 0, s61
    s_lshr_b32 s20, s61, 3
    s_and_b32 s21, s61, 7
    s_cmp_ge_u32 s20, 3
    s_cselect_b32 s54, 11, 10
    s_sub_u32 s58, s20, 2
    s_max_i32 s58, s58, 0
    s_cmp_ge_u32 s48, 12
    s_cselect_b32 s58, 3, s58
    s_lshl_b32 s51, s21, 7
    s_cmp_eq_u32 s20, 4
    s_cselect_b32 s22, 1024, 0
    s_add_u32 s51, s51, s22
    s_lshl_b32 s62, s48, 1
    s_add_u32 s20, s62, 1
    s_add_u32 s21, s62, 4
    s_cmp_ge_u32 s48, 12
    s_cselect_b32 s62, s21, s20
    s_lshr_b32 s20, s62, 3
    s_and_b32 s21, s62, 7
    s_cmp_ge_u32 s20, 3
    s_cselect_b32 s55, 11, 10
    s_sub_u32 s59, s20, 2
    s_max_i32 s59, s59, 0
    s_lshl_b32 s52, s21, 7
    s_cmp_eq_u32 s20, 4
    s_cselect_b32 s22, 1024, 0
    s_add_u32 s52, s52, s22
    s_add_u32 s20, s48, 32
    s_add_u32 s21, s48, 16
    s_cmp_ge_u32 s48, 8
    s_cselect_b32 s20, s21, s20
    s_lshl_b32 s21, s48, 1
    s_add_u32 s21, s21, 5
    s_cmp_ge_u32 s48, 12
    s_cselect_b32 s63, s21, s20
    s_lshr_b32 s20, s63, 3
    s_and_b32 s21, s63, 7
    s_cmp_ge_u32 s20, 3
    s_cselect_b32 s56, 11, 10
    s_sub_u32 s60, s20, 2
    s_max_i32 s60, s60, 0
    s_lshl_b32 s53, s21, 7
    s_cmp_eq_u32 s20, 4
    s_cselect_b32 s22, 1024, 0
    s_add_u32 s53, s53, s22
    s_lshr_b32 s22, s47, 3
    s_mul_i32 s22, s22, 1000
    s_and_b32 s20, s47, 7
    s_lshl_b32 s20, s20, 7
    s_add_u32 s50, s22, s20
    s_lshl_b32 s50, s50, 10
    s_branch K1D_2
K1F_1:
    s_sub_u32 s20, s20, 4
    s_mul_i32 s20, s20, 6
    s_sub_u32 s21, s21, 24
    s_add_u32 s20, s20, s21
    s_cmp_ge_u32 s20, 12
    s_cselect_b32 s22, 1, 0
    s_mul_i32 s21, s22, 12
    s_sub_u32 s20, s20, s21
    s_mul_i32 s47, s20, 21846
    s_lshr_b32 s47, s47, 16
    s_mul_i32 s21, s47, 3
    s_sub_u32 s48, s20, s21
    s_lshl_b32 s50, s47, 17
    s_mov_b32 s54, 10
    s_mul_i32 s61, s48, 3
    s_add_u32 s61, s61, 0
    s_cmp_ge_u32 s61, 8
    s_cselect_b32 s58, 3, 0
    s_min_u32 s61, s61, 7
    s_lshl_b32 s51, s61, 7
    s_lshl_b32 s20, s22, 19
    s_add_u32 s51, s51, s20
    s_mov_b32 s55, 10
    s_mul_i32 s62, s48, 3
    s_add_u32 s62, s62, 1
    s_cmp_ge_u32 s62, 8
    s_cselect_b32 s59, 3, 0
    s_min_u32 s62, s62, 7
    s_lshl_b32 s52, s62, 7
    s_lshl_b32 s20, s22, 19
    s_add_u32 s52, s52, s20
    s_mov_b32 s56, 10
    s_mul_i32 s63, s48, 3
    s_add_u32 s63, s63, 2
    s_cmp_ge_u32 s63, 8
    s_cselect_b32 s60, 3, 0
    s_min_u32 s63, s63, 7
    s_lshl_b32 s53, s63, 7
    s_lshl_b32 s20, s22, 19
    s_add_u32 s53, s53, s20
    s_add_u32 s49, s22, 1
K1D_2:
    v_lshrrev_b32 v152, 3, v151
    v_and_b32 v153, 7, v151
    v_lshrrev_b32 v154, 1, v152
    v_xor_b32 v155, v154, v153
    s_lshl_b32 s20, s44, 4
    v_add_u32 v156, s20, v152
    v_lshlrev_b32 v156, 10, v156
    v_add_u32 v156, s50, v156
    s_mov_b32 s50, 0
    v_lshl_add_u32 v146, v155, 4, v156
    v_xor_b32 v155, 4, v155
    v_add_u32 v156, 8192, v156
    v_lshl_add_u32 v147, v155, 4, v156
    v_and_b32 v154, 1, v154
    s_and_b32 s20, s44, 1
    s_lshl_b32 s20, s20, 1
    v_or_b32 v154, s20, v154
    v_lshlrev_b32 v154, 1, v154
    v_xor_b32 v154, v154, v153
    v_lshlrev_b32 v154, 4, v154
    s_lshl_b32 s20, s44, 3
    v_add_u32 v152, s20, v152
    v_lshlrev_b32 v148, s54, v152
    v_add_u32 v148, v148, v154
    v_add_u32 v148, s51, v148
    s_add_u32 s54, s54, 6
    v_lshlrev_b32 v149, s55, v152
    v_add_u32 v149, v149, v154
    v_add_u32 v149, s52, v149
    s_add_u32 s55, s55, 6
    v_lshlrev_b32 v150, s56, v152
    v_add_u32 v150, v150, v154
    v_add_u32 v150, s53, v150
    s_add_u32 s56, s56, 6
    s_lshr_b32 s21, s2, 3
    s_and_b32 s20, s21, 3
    s_lshl_b32 s20, s20, 1
    s_lshr_b32 s21, s21, 2
    s_add_u32 s20, s20, s21
    s_and_b32 s21, s2, 1
    s_add_u32 s20, s20, s21
    s_mul_i32 s21, s48, 3
    s_lshl_b32 s22, s47, 1
    s_add_u32 s21, s21, s22
    s_cmp_lg_u32 s49, 0
    s_cselect_b32 s23, s21, s20
    s_and_b32 s23, s23, 7
    s_lshr_b32 s21, s2, 3
    s_lshr_b32 s20, s21, 2
    s_add_u32 s20, s20, s21
    s_and_b32 s20, s20, 1
    s_lshl_b32 s23, s20, 2
    s_cmp_lg_u32 s49, 0
    s_cselect_b32 s23, 0, s23
    s_lshl_b32 s50, s23, 7
    s_waitcnt lgkmcnt(0)
    s_mov_b32 s28, s98
    s_mov_b32 s29, s99
    s_mov_b32 s30, 20643840
    s_mov_b32 s31, 131072
    s_mov_b32 s27, 131072
    s_mov_b32 s35, 131072
    s_mov_b32 s39, 131072
    s_mov_b32 s43, 131072
    s_cmp_lg_u32 s49, 0
    s_cbranch_scc1 K1F2_3
    s_mov_b32 s24, s4
    s_mov_b32 s25, s5
    s_mov_b32 s26, 2048000
    s_lshr_b32 s20, s61, 3
    s_cmp_eq_u32 s20, 1
    s_cselect_b32 s32, s8, s6
    s_cselect_b32 s33, s9, s7
    s_cmp_eq_u32 s20, 2
    s_cselect_b32 s32, s10, s32
    s_cselect_b32 s33, s11, s33
    s_cmp_ge_u32 s20, 3
    s_cselect_b32 s32, s14, s32
    s_cselect_b32 s33, s15, s33
    s_mov_b32 s34, 524288
    s_cselect_b32 s34, 1048576, s34
    s_lshr_b32 s20, s62, 3
    s_cmp_eq_u32 s20, 1
    s_cselect_b32 s36, s8, s6
    s_cselect_b32 s37, s9, s7
    s_cmp_eq_u32 s20, 2
    s_cselect_b32 s36, s10, s36
    s_cselect_b32 s37, s11, s37
    s_cmp_ge_u32 s20, 3
    s_cselect_b32 s36, s14, s36
    s_cselect_b32 s37, s15, s37
    s_mov_b32 s38, 524288
    s_cselect_b32 s38, 1048576, s38
    s_lshr_b32 s20, s63, 3
    s_cmp_eq_u32 s20, 1
    s_cselect_b32 s40, s8, s6
    s_cselect_b32 s41, s9, s7
    s_cmp_eq_u32 s20, 2
    s_cselect_b32 s40, s10, s40
    s_cselect_b32 s41, s11, s41
    s_cmp_ge_u32 s20, 3
    s_cselect_b32 s40, s14, s40
    s_cselect_b32 s41, s15, s41
    s_mov_b32 s42, 524288
    s_cselect_b32 s42, 1048576, s42
    s_branch K1D2_4
K1F2_3:
    s_cmp_eq_u32 s49, 2
    s_cselect_b32 s24, s18, s12
    s_cselect_b32 s25, s19, s13
    s_mov_b32 s26, 524288
    s_mov_b32 s32, s100
    s_mov_b32 s33, s101
    s_mov_b32 s34, 1048576
    s_mov_b32 s36, s100
    s_mov_b32 s37, s101
    s_mov_b32 s38, 1048576
    s_mov_b32 s40, s100
    s_mov_b32 s41, s101
    s_mov_b32 s42, 1048576
K1D2_4:
    s_lshl_b32 s20, s57, 1
    s_add_u32 m0, s20, 0
    s_nop 0
    buffer_load_dwordx4 v146, s[24:27], s50 offen nt lds
    s_add_u32 m0, m0, 1024
    s_nop 0
    buffer_load_dwordx4 v147, s[24:27], s50 offen nt lds
    s_lshl_b32 s51, s23, s54
    s_add_u32 m0, s57, 16384
    s_nop 0
    buffer_load_dwordx4 v148, s[32:35], s51 offen lds
    s_lshl_b32 s52, s23, s55
    s_add_u32 m0, s57, 24576
    s_nop 0
    buffer_load_dwordx4 v149, s[36:39], s52 offen lds
    s_lshl_b32 s53, s23, s56
    s_add_u32 m0, s57, 32768
    s_nop 0
    buffer_load_dwordx4 v150, s[40:43], s53 offen lds
    s_add_u32 s23, s23, 1
    s_and_b32 s23, s23, 7
    s_lshl_b32 s50, s23, 7
    s_barrier
    s_lshl_b32 s20, s57, 1
    s_add_u32 m0, s20, 40960
    s_nop 0
    buffer_load_dwordx4 v146, s[24:27], s50 offen nt lds
    s_add_u32 m0, m0, 1024
    s_nop 0
    buffer_load_dwordx4 v147, s[24:27], s50 offen nt lds
    s_lshl_b32 s51, s23, s54
    s_add_u32 m0, s57, 57344
    s_nop 0
    buffer_load_dwordx4 v148, s[32:35], s51 offen lds
    s_lshl_b32 s52, s23, s55
    s_add_u32 m0, s57, 65536
    s_nop 0
    buffer_load_dwordx4 v149, s[36:39], s52 offen lds
    s_lshl_b32 s53, s23, s56
    s_add_u32 m0, s57, 73728
    s_nop 0
    buffer_load_dwordx4 v150, s[40:43], s53 offen lds
    s_add_u32 s23, s23, 1
    s_and_b32 s23, s23, 7
    s_lshl_b32 s50, s23, 7
    v_and_b32 v152, 15, v151
    v_lshrrev_b32 v153, 4, v151
    v_lshrrev_b32 v154, 1, v152
    v_xor_b32 v154, v154, v153
    v_lshlrev_b32 v154, 4, v154
    v_lshl_add_u32 v154, v152, 7, v154
    s_lshl_b32 s20, s45, 13
    v_add_u32 v136, s20, v154
    v_xor_b32 v137, 64, v136
    s_lshl_b32 s20, s46, 11
    v_add_u32 v140, s20, v136
    v_add_u32 v141, s20, v137
    v_add_u32 v138, 81920, v136
    v_add_u32 v139, 81920, v137
    v_add_u32 v142, 81920, v140
    v_add_u32 v143, 81920, v141
    v_bfe_u32 v154, v151, 2, 2
    v_lshl_add_u32 v155, v153, 3, v154
    v_lshlrev_b32 v155, 7, v155
    v_lshrrev_b32 v154, 1, v154
    v_and_b32 v156, 1, v153
    v_lshl_or_b32 v154, v156, 1, v154
    v_lshlrev_b32 v154, 1, v154
    v_bfe_u32 v156, v151, 1, 1
    s_lshl_b32 s20, s46, 1
    v_or_b32 v156, s20, v156
    v_xor_b32 v154, v154, v156
    v_lshl_add_u32 v155, v154, 4, v155
    v_and_b32 v156, 1, v151
    v_lshl_add_u32 v155, v156, 3, v155
    v_add_u32 v144, 16384, v155
    v_add_u32 v145, 98304, v155
    v_and_b32 v152, 15, v151
    v_lshrrev_b32 v153, 4, v151
    v_and_b32 v166, 3, v152
    s_lshl_b32 s20, s44, 4
    v_add_u32 v154, s20, v152
    v_lshlrev_b32 v158, 3, v154
    v_lshlrev_b32 v155, 4, v153
    s_mul_i32 s20, s44, 192
    v_add_u32 v159, s20, v155
    s_mul_i32 s20, s46, 192
    v_add_u32 v160, s20, v155
    s_lshl_b32 s20, s45, 9
    v_lshl_add_u32 v161, v152, 3, s20
    v_lshlrev_b32 v162, 4, v151
    v_and_b32 v154, 1, v153
    v_lshl_add_u32 v154, v154, 4, v152
    v_lshrrev_b32 v155, 1, v153
    s_lshl_b32 s20, s46, 1
    v_or_b32 v156, s20, v155
    v_and_b32 v163, 7, v152
    v_xor_b32 v156, v156, v163
    v_lshlrev_b32 v156, 4, v156
    v_lshl_add_u32 v163, v154, 7, v156
    s_lshl_b32 s20, s45, 13
    v_add_u32 v163, s20, v163
    v_lshlrev_b32 v164, 3, v154
    v_lshl_add_u32 v164, v155, 2, v164
    s_lshl_b32 s20, s46, 10
    s_lshl_b32 s21, s45, 9
    s_add_u32 s20, s20, s21
    v_add_u32 v164, s20, v164
    v_mov_b32 v165, 0xc0135761
    v_lshrrev_b32 v154, 3, v151
    v_and_b32 v155, 7, v151
    v_xor_b32 v156, v155, v154
    v_lshlrev_b32 v156, 4, v156
    v_lshl_add_u32 v156, v154, 7, v156
    s_lshl_b32 s20, s44, 11
    v_add_u32 v168, s20, v156
    v_lshlrev_b32 v154, 10, v154
    v_lshl_add_u32 v167, v155, 4, v154
    s_lshl_b32 s20, s44, 8
    v_lshl_add_u32 v169, v151, 2, s20
    v_lshrrev_b32 v155, 2, v152
    v_cmp_eq_u32 s[94:95], v155, v153
    v_cmp_eq_u32 s[96:97], 0, v152
    v_mov_b32 v132, 0x3f803f80
    v_mov_b32 v133, 0x3f803f80
    v_mov_b32 v134, 0x3f803f80
    v_mov_b32 v135, 0x3f803f80
    v_mov_b32 v56, 0
    v_mov_b32 v57, 0
    v_mov_b32 v58, 0
    v_mov_b32 v59, 0
    v_mov_b32 v60, 0
    v_mov_b32 v61, 0
    v_mov_b32 v62, 0
    v_mov_b32 v63, 0
    v_mov_b32 v64, 0
    v_mov_b32 v65, 0
    v_mov_b32 v66, 0
    v_mov_b32 v67, 0
    s_waitcnt vmcnt(5)
    s_barrier
    s_cmp_lg_u32 s49, 0
    s_cbranch_scc1 K1V_7
    s_cmp_eq_u32 s45, 1
    s_cbranch_scc1 K1V_6
K1V_5:
    ds_read_b128 v[68:71], v136 offset:0
    ds_read_b128 v[72:75], v136 offset:2048
    ds_read_b128 v[76:79], v136 offset:4096
    ds_read_b128 v[80:83], v136 offset:6144
    ds_read_b128 v[84:87], v140 offset:0
    ds_read_b64_tr_b16 v[88:89], v144 offset:0
    ds_read_b64_tr_b16 v[90:91], v144 offset:512
    ds_read_b64_tr_b16 v[92:93], v144 offset:8192
    ds_read_b64_tr_b16 v[94:95], v144 offset:8704
    ds_read_b64_tr_b16 v[96:97], v144 offset:16384
    ds_read_b64_tr_b16 v[98:99], v144 offset:16896
    s_waitcnt lgkmcnt(0)
    v_mfma_f32_16x16x32_bf16 v[0:3], v[88:91], v[68:71], 0
    ds_read_b128 v[100:103], v137 offset:0
    s_lshl_b32 s20, s57, 1
    s_add_u32 m0, s20, 81920
    v_mfma_f32_16x16x32_bf16 v[4:7], v[88:91], v[72:75], 0
    buffer_load_dwordx4 v146, s[24:27], s50 offen nt lds
    ds_read_b128 v[104:107], v137 offset:2048
    v_mfma_f32_16x16x32_bf16 v[8:11], v[88:91], v[76:79], 0
    ds_read_b128 v[108:111], v137 offset:4096
    v_mfma_f32_16x16x32_bf16 v[12:15], v[88:91], v[80:83], 0
    ds_read_b128 v[112:115], v137 offset:6144
    s_add_u32 m0, m0, 1024
    v_mfma_f32_16x16x32_bf16 v[48:51], v[132:135], v[84:87], 0
    buffer_load_dwordx4 v147, s[24:27], s50 offen nt lds
    ds_read_b128 v[116:119], v141 offset:0
    v_mfma_f32_16x16x32_bf16 v[16:19], v[92:95], v[68:71], 0
    ds_read_b64_tr_b16 v[120:121], v144 offset:4096
    v_mfma_f32_16x16x32_bf16 v[20:23], v[92:95], v[72:75], 0
    ds_read_b64_tr_b16 v[122:123], v144 offset:4608
    s_lshl_b32 s51, s23, s54
    s_add_u32 m0, s57, 98304
    v_mfma_f32_16x16x32_bf16 v[24:27], v[92:95], v[76:79], 0
    buffer_load_dwordx4 v148, s[32:35], s51 offen lds
    ds_read_b64_tr_b16 v[124:125], v144 offset:12288
    v_mfma_f32_16x16x32_bf16 v[28:31], v[92:95], v[80:83], 0
    ds_read_b64_tr_b16 v[126:127], v144 offset:12800
    v_mfma_f32_16x16x32_bf16 v[52:55], v[84:87], v[84:87], 0
    ds_read_b64_tr_b16 v[128:129], v144 offset:20480
    s_lshl_b32 s52, s23, s55
    s_add_u32 m0, s57, 106496
    v_mfma_f32_16x16x32_bf16 v[32:35], v[96:99], v[68:71], 0
    buffer_load_dwordx4 v149, s[36:39], s52 offen lds
    ds_read_b64_tr_b16 v[130:131], v144 offset:20992
    v_mfma_f32_16x16x32_bf16 v[36:39], v[96:99], v[72:75], 0
    v_mfma_f32_16x16x32_bf16 v[40:43], v[96:99], v[76:79], 0
    s_lshl_b32 s53, s23, s56
    s_add_u32 m0, s57, 114688
    v_mfma_f32_16x16x32_bf16 v[44:47], v[96:99], v[80:83], 0
    buffer_load_dwordx4 v150, s[40:43], s53 offen lds
    s_add_u32 s23, s23, 1
    s_and_b32 s23, s23, 7
    s_lshl_b32 s50, s23, 7
    v_mfma_f32_16x16x32_bf16 v[56:59], v[88:91], v[132:135], v[56:59]
    v_mfma_f32_16x16x32_bf16 v[64:67], v[96:99], v[132:135], v[64:67]
    s_waitcnt vmcnt(5) lgkmcnt(0)
    s_barrier
    v_mfma_f32_16x16x32_bf16 v[0:3], v[120:123], v[100:103], v[0:3]
    ds_read_b128 v[68:71], v136 offset:40960
    s_lshl_b32 s20, s57, 1
    s_add_u32 m0, s20, 0
    v_mfma_f32_16x16x32_bf16 v[4:7], v[120:123], v[104:107], v[4:7]
    buffer_load_dwordx4 v146, s[24:27], s50 offen nt lds
    ds_read_b128 v[72:75], v136 offset:43008
    v_mfma_f32_16x16x32_bf16 v[8:11], v[120:123], v[108:111], v[8:11]
    ds_read_b128 v[76:79], v136 offset:45056
    v_mfma_f32_16x16x32_bf16 v[12:15], v[120:123], v[112:115], v[12:15]
    ds_read_b128 v[80:83], v136 offset:47104
    v_mfma_f32_16x16x32_bf16 v[48:51], v[132:135], v[116:119], v[48:51]
    ds_read_b128 v[84:87], v140 offset:40960
    s_add_u32 m0, m0, 1024
    v_mfma_f32_16x16x32_bf16 v[16:19], v[124:127], v[100:103], v[16:19]
    buffer_load_dwordx4 v147, s[24:27], s50 offen nt lds
    ds_read_b64_tr_b16 v[88:89], v144 offset:40960
    v_mfma_f32_16x16x32_bf16 v[20:23], v[124:127], v[104:107], v[20:23]
    ds_read_b64_tr_b16 v[90:91], v144 offset:41472
    v_mfma_f32_16x16x32_bf16 v[24:27], v[124:127], v[108:111], v[24:27]
    ds_read_b64_tr_b16 v[92:93], v144 offset:49152
    v_mfma_f32_16x16x32_bf16 v[28:31], v[124:127], v[112:115], v[28:31]
    ds_read_b64_tr_b16 v[94:95], v144 offset:49664
    v_mfma_f32_16x16x32_bf16 v[52:55], v[116:119], v[116:119], v[52:55]
    ds_read_b64_tr_b16 v[96:97], v144 offset:57344
    s_lshl_b32 s51, s23, s54
    s_add_u32 m0, s57, 16384
    v_mfma_f32_16x16x32_bf16 v[32:35], v[128:131], v[100:103], v[32:35]
    buffer_load_dwordx4 v148, s[32:35], s51 offen lds
    ds_read_b64_tr_b16 v[98:99], v144 offset:57856
    v_mfma_f32_16x16x32_bf16 v[36:39], v[128:131], v[104:107], v[36:39]
    v_mfma_f32_16x16x32_bf16 v[40:43], v[128:131], v[108:111], v[40:43]
    v_mfma_f32_16x16x32_bf16 v[44:47], v[128:131], v[112:115], v[44:47]
    v_mfma_f32_16x16x32_bf16 v[60:63], v[124:127], v[132:135], v[60:63]
    s_waitcnt lgkmcnt(0)
    v_mfma_f32_16x16x32_bf16 v[0:3], v[88:91], v[68:71], v[0:3]
    ds_read_b128 v[100:103], v137 offset:40960
    s_lshl_b32 s52, s23, s55
    s_add_u32 m0, s57, 24576
    v_mfma_f32_16x16x32_bf16 v[4:7], v[88:91], v[72:75], v[4:7]
    buffer_load_dwordx4 v149, s[36:39], s52 offen lds
    ds_read_b128 v[104:107], v137 offset:43008
    v_mfma_f32_16x16x32_bf16 v[8:11], v[88:91], v[76:79], v[8:11]
    ds_read_b128 v[108:111], v137 offset:45056
    v_mfma_f32_16x16x32_bf16 v[12:15], v[88:91], v[80:83], v[12:15]
    ds_read_b128 v[112:115], v137 offset:47104
    v_mfma_f32_16x16x32_bf16 v[48:51], v[132:135], v[84:87], v[48:51]
    ds_read_b128 v[116:119], v141 offset:40960
    v_mfma_f32_16x16x32_bf16 v[16:19], v[92:95], v[68:71], v[16:19]
    ds_read_b64_tr_b16 v[120:121], v144 offset:45056
    v_mfma_f32_16x16x32_bf16 v[20:23], v[92:95], v[72:75], v[20:23]
    ds_read_b64_tr_b16 v[122:123], v144 offset:45568
    v_mfma_f32_16x16x32_bf16 v[24:27], v[92:95], v[76:79], v[24:27]
    ds_read_b64_tr_b16 v[124:125], v144 offset:53248
    s_lshl_b32 s53, s23, s56
    s_add_u32 m0, s57, 32768
    v_mfma_f32_16x16x32_bf16 v[28:31], v[92:95], v[80:83], v[28:31]
    buffer_load_dwordx4 v150, s[40:43], s53 offen lds
    s_add_u32 s23, s23, 1
    s_and_b32 s23, s23, 7
    s_lshl_b32 s50, s23, 7
    ds_read_b64_tr_b16 v[126:127], v144 offset:53760
    v_mfma_f32_16x16x32_bf16 v[52:55], v[84:87], v[84:87], v[52:55]
    ds_read_b64_tr_b16 v[128:129], v144 offset:61440
    v_mfma_f32_16x16x32_bf16 v[32:35], v[96:99], v[68:71], v[32:35]
    ds_read_b64_tr_b16 v[130:131], v144 offset:61952
    v_mfma_f32_16x16x32_bf16 v[36:39], v[96:99], v[72:75], v[36:39]
    v_mfma_f32_16x16x32_bf16 v[40:43], v[96:99], v[76:79], v[40:43]
    v_mfma_f32_16x16x32_bf16 v[44:47], v[96:99], v[80:83], v[44:47]
    v_mfma_f32_16x16x32_bf16 v[56:59], v[88:91], v[132:135], v[56:59]
    v_mfma_f32_16x16x32_bf16 v[64:67], v[96:99], v[132:135], v[64:67]
    s_waitcnt vmcnt(5) lgkmcnt(0)
    s_barrier
    v_mfma_f32_16x16x32_bf16 v[0:3], v[120:123], v[100:103], v[0:3]
    ds_read_b128 v[68:71], v138 offset:0
    s_lshl_b32 s20, s57, 1
    s_add_u32 m0, s20, 40960
    v_mfma_f32_16x16x32_bf16 v[4:7], v[120:123], v[104:107], v[4:7]
    buffer_load_dwordx4 v146, s[24:27], s50 offen nt lds
    ds_read_b128 v[72:75], v138 offset:2048
    v_mfma_f32_16x16x32_bf16 v[8:11], v[120:123], v[108:111], v[8:11]
    ds_read_b128 v[76:79], v138 offset:4096
    v_mfma_f32_16x16x32_bf16 v[12:15], v[120:123], v[112:115], v[12:15]
    ds_read_b128 v[80:83], v138 offset:6144
    v_mfma_f32_16x16x32_bf16 v[48:51], v[132:135], v[116:119], v[48:51]
    ds_read_b128 v[84:87], v142 offset:0
    s_add_u32 m0, m0, 1024
    v_mfma_f32_16x16x32_bf16 v[16:19], v[124:127], v[100:103], v[16:19]
    buffer_load_dwordx4 v147, s[24:27], s50 offen nt lds
    ds_read_b64_tr_b16 v[88:89], v145 offset:0
    v_mfma_f32_16x16x32_bf16 v[20:23], v[124:127], v[104:107], v[20:23]
    ds_read_b64_tr_b16 v[90:91], v145 offset:512
    v_mfma_f32_16x16x32_bf16 v[24:27], v[124:127], v[108:111], v[24:27]
    ds_read_b64_tr_b16 v[92:93], v145 offset:8192
    v_mfma_f32_16x16x32_bf16 v[28:31], v[124:127], v[112:115], v[28:31]
    ds_read_b64_tr_b16 v[94:95], v145 offset:8704
    v_mfma_f32_16x16x32_bf16 v[52:55], v[116:119], v[116:119], v[52:55]
    ds_read_b64_tr_b16 v[96:97], v145 offset:16384
    s_lshl_b32 s51, s23, s54
    s_add_u32 m0, s57, 57344
    v_mfma_f32_16x16x32_bf16 v[32:35], v[128:131], v[100:103], v[32:35]
    buffer_load_dwordx4 v148, s[32:35], s51 offen lds
    ds_read_b64_tr_b16 v[98:99], v145 offset:16896
    v_mfma_f32_16x16x32_bf16 v[36:39], v[128:131], v[104:107], v[36:39]
    v_mfma_f32_16x16x32_bf16 v[40:43], v[128:131], v[108:111], v[40:43]
    v_mfma_f32_16x16x32_bf16 v[44:47], v[128:131], v[112:115], v[44:47]
    v_mfma_f32_16x16x32_bf16 v[60:63], v[124:127], v[132:135], v[60:63]
    s_waitcnt lgkmcnt(0)
    v_mfma_f32_16x16x32_bf16 v[0:3], v[88:91], v[68:71], v[0:3]
    ds_read_b128 v[100:103], v139 offset:0
    s_lshl_b32 s52, s23, s55
    s_add_u32 m0, s57, 65536
    v_mfma_f32_16x16x32_bf16 v[4:7], v[88:91], v[72:75], v[4:7]
    buffer_load_dwordx4 v149, s[36:39], s52 offen lds
    ds_read_b128 v[104:107], v139 offset:2048
    v_mfma_f32_16x16x32_bf16 v[8:11], v[88:91], v[76:79], v[8:11]
    ds_read_b128 v[108:111], v139 offset:4096
    v_mfma_f32_16x16x32_bf16 v[12:15], v[88:91], v[80:83], v[12:15]
    ds_read_b128 v[112:115], v139 offset:6144
    v_mfma_f32_16x16x32_bf16 v[48:51], v[132:135], v[84:87], v[48:51]
    ds_read_b128 v[116:119], v143 offset:0
    v_mfma_f32_16x16x32_bf16 v[16:19], v[92:95], v[68:71], v[16:19]
    ds_read_b64_tr_b16 v[120:121], v145 offset:4096
    v_mfma_f32_16x16x32_bf16 v[20:23], v[92:95], v[72:75], v[20:23]
    ds_read_b64_tr_b16 v[122:123], v145 offset:4608
    v_mfma_f32_16x16x32_bf16 v[24:27], v[92:95], v[76:79], v[24:27]
    ds_read_b64_tr_b16 v[124:125], v145 offset:12288
    s_lshl_b32 s53, s23, s56
    s_add_u32 m0, s57, 73728
    v_mfma_f32_16x16x32_bf16 v[28:31], v[92:95], v[80:83], v[28:31]
    buffer_load_dwordx4 v150, s[40:43], s53 offen lds
    s_add_u32 s23, s23, 1
    s_and_b32 s23, s23, 7
    s_lshl_b32 s50, s23, 7
    ds_read_b64_tr_b16 v[126:127], v145 offset:12800
    v_mfma_f32_16x16x32_bf16 v[52:55], v[84:87], v[84:87], v[52:55]
    ds_read_b64_tr_b16 v[128:129], v145 offset:20480
    v_mfma_f32_16x16x32_bf16 v[32:35], v[96:99], v[68:71], v[32:35]
    ds_read_b64_tr_b16 v[130:131], v145 offset:20992
    v_mfma_f32_16x16x32_bf16 v[36:39], v[96:99], v[72:75], v[36:39]
    v_mfma_f32_16x16x32_bf16 v[40:43], v[96:99], v[76:79], v[40:43]
    v_mfma_f32_16x16x32_bf16 v[44:47], v[96:99], v[80:83], v[44:47]
    v_mfma_f32_16x16x32_bf16 v[56:59], v[88:91], v[132:135], v[56:59]
    v_mfma_f32_16x16x32_bf16 v[64:67], v[96:99], v[132:135], v[64:67]
    s_waitcnt vmcnt(5) lgkmcnt(0)
    s_barrier
    v_mfma_f32_16x16x32_bf16 v[0:3], v[120:123], v[100:103], v[0:3]
    ds_read_b128 v[68:71], v136 offset:0
    s_lshl_b32 s20, s57, 1
    s_add_u32 m0, s20, 81920
    v_mfma_f32_16x16x32_bf16 v[4:7], v[120:123], v[104:107], v[4:7]
    buffer_load_dwordx4 v146, s[24:27], s50 offen nt lds
    ds_read_b128 v[72:75], v136 offset:2048
    v_mfma_f32_16x16x32_bf16 v[8:11], v[120:123], v[108:111], v[8:11]
    ds_read_b128 v[76:79], v136 offset:4096
    v_mfma_f32_16x16x32_bf16 v[12:15], v[120:123], v[112:115], v[12:15]
    ds_read_b128 v[80:83], v136 offset:6144
    v_mfma_f32_16x16x32_bf16 v[48:51], v[132:135], v[116:119], v[48:51]
    ds_read_b128 v[84:87], v140 offset:0
    s_add_u32 m0, m0, 1024
    v_mfma_f32_16x16x32_bf16 v[16:19], v[124:127], v[100:103], v[16:19]
    buffer_load_dwordx4 v147, s[24:27], s50 offen nt lds
    ds_read_b64_tr_b16 v[88:89], v144 offset:0
    v_mfma_f32_16x16x32_bf16 v[20:23], v[124:127], v[104:107], v[20:23]
    ds_read_b64_tr_b16 v[90:91], v144 offset:512
    v_mfma_f32_16x16x32_bf16 v[24:27], v[124:127], v[108:111], v[24:27]
    ds_read_b64_tr_b16 v[92:93], v144 offset:8192
    v_mfma_f32_16x16x32_bf16 v[28:31], v[124:127], v[112:115], v[28:31]
    ds_read_b64_tr_b16 v[94:95], v144 offset:8704
    v_mfma_f32_16x16x32_bf16 v[52:55], v[116:119], v[116:119], v[52:55]
    ds_read_b64_tr_b16 v[96:97], v144 offset:16384
    s_lshl_b32 s51, s23, s54
    s_add_u32 m0, s57, 98304
    v_mfma_f32_16x16x32_bf16 v[32:35], v[128:131], v[100:103], v[32:35]
    buffer_load_dwordx4 v148, s[32:35], s51 offen lds
    ds_read_b64_tr_b16 v[98:99], v144 offset:16896
    v_mfma_f32_16x16x32_bf16 v[36:39], v[128:131], v[104:107], v[36:39]
    v_mfma_f32_16x16x32_bf16 v[40:43], v[128:131], v[108:111], v[40:43]
    v_mfma_f32_16x16x32_bf16 v[44:47], v[128:131], v[112:115], v[44:47]
    v_mfma_f32_16x16x32_bf16 v[60:63], v[124:127], v[132:135], v[60:63]
    s_waitcnt lgkmcnt(0)
    v_mfma_f32_16x16x32_bf16 v[0:3], v[88:91], v[68:71], v[0:3]
    ds_read_b128 v[100:103], v137 offset:0
    s_lshl_b32 s52, s23, s55
    s_add_u32 m0, s57, 106496
    v_mfma_f32_16x16x32_bf16 v[4:7], v[88:91], v[72:75], v[4:7]
    buffer_load_dwordx4 v149, s[36:39], s52 offen lds
    ds_read_b128 v[104:107], v137 offset:2048
    v_mfma_f32_16x16x32_bf16 v[8:11], v[88:91], v[76:79], v[8:11]
    ds_read_b128 v[108:111], v137 offset:4096
    v_mfma_f32_16x16x32_bf16 v[12:15], v[88:91], v[80:83], v[12:15]
    ds_read_b128 v[112:115], v137 offset:6144
    v_mfma_f32_16x16x32_bf16 v[48:51], v[132:135], v[84:87], v[48:51]
    ds_read_b128 v[116:119], v141 offset:0
    v_mfma_f32_16x16x32_bf16 v[16:19], v[92:95], v[68:71], v[16:19]
    ds_read_b64_tr_b16 v[120:121], v144 offset:4096
    v_mfma_f32_16x16x32_bf16 v[20:23], v[92:95], v[72:75], v[20:23]
    ds_read_b64_tr_b16 v[122:123], v144 offset:4608
    v_mfma_f32_16x16x32_bf16 v[24:27], v[92:95], v[76:79], v[24:27]
    ds_read_b64_tr_b16 v[124:125], v144 offset:12288
    s_lshl_b32 s53, s23, s56
    s_add_u32 m0, s57, 114688
    v_mfma_f32_16x16x32_bf16 v[28:31], v[92:95], v[80:83], v[28:31]
    buffer_load_dwordx4 v150, s[40:43], s53 offen lds
    s_add_u32 s23, s23, 1
    s_and_b32 s23, s23, 7
    s_lshl_b32 s50, s23, 7
    ds_read_b64_tr_b16 v[126:127], v144 offset:12800
    v_mfma_f32_16x16x32_bf16 v[52:55], v[84:87], v[84:87], v[52:55]
    ds_read_b64_tr_b16 v[128:129], v144 offset:20480
    v_mfma_f32_16x16x32_bf16 v[32:35], v[96:99], v[68:71], v[32:35]
    ds_read_b64_tr_b16 v[130:131], v144 offset:20992
    v_mfma_f32_16x16x32_bf16 v[36:39], v[96:99], v[72:75], v[36:39]
    v_mfma_f32_16x16x32_bf16 v[40:43], v[96:99], v[76:79], v[40:43]
    v_mfma_f32_16x16x32_bf16 v[44:47], v[96:99], v[80:83], v[44:47]
    v_mfma_f32_16x16x32_bf16 v[56:59], v[88:91], v[132:135], v[56:59]
    v_mfma_f32_16x16x32_bf16 v[64:67], v[96:99], v[132:135], v[64:67]
    s_waitcnt vmcnt(5) lgkmcnt(0)
    s_barrier
    v_mfma_f32_16x16x32_bf16 v[0:3], v[120:123], v[100:103], v[0:3]
    ds_read_b128 v[68:71], v136 offset:40960
    s_lshl_b32 s20, s57, 1
    s_add_u32 m0, s20, 0
    v_mfma_f32_16x16x32_bf16 v[4:7], v[120:123], v[104:107], v[4:7]
    buffer_load_dwordx4 v146, s[24:27], s50 offen nt lds
    ds_read_b128 v[72:75], v136 offset:43008
    v_mfma_f32_16x16x32_bf16 v[8:11], v[120:123], v[108:111], v[8:11]
    ds_read_b128 v[76:79], v136 offset:45056
    v_mfma_f32_16x16x32_bf16 v[12:15], v[120:123], v[112:115], v[12:15]
    ds_read_b128 v[80:83], v136 offset:47104
    v_mfma_f32_16x16x32_bf16 v[48:51], v[132:135], v[116:119], v[48:51]
    ds_read_b128 v[84:87], v140 offset:40960
    s_add_u32 m0, m0, 1024
    v_mfma_f32_16x16x32_bf16 v[16:19], v[124:127], v[100:103], v[16:19]
    buffer_load_dwordx4 v147, s[24:27], s50 offen nt lds
    ds_read_b64_tr_b16 v[88:89], v144 offset:40960
    v_mfma_f32_16x16x32_bf16 v[20:23], v[124:127], v[104:107], v[20:23]
    ds_read_b64_tr_b16 v[90:91], v144 offset:41472
    v_mfma_f32_16x16x32_bf16 v[24:27], v[124:127], v[108:111], v[24:27]
    ds_read_b64_tr_b16 v[92:93], v144 offset:49152
    v_mfma_f32_16x16x32_bf16 v[28:31], v[124:127], v[112:115], v[28:31]
    ds_read_b64_tr_b16 v[94:95], v144 offset:49664
    v_mfma_f32_16x16x32_bf16 v[52:55], v[116:119], v[116:119], v[52:55]
    ds_read_b64_tr_b16 v[96:97], v144 offset:57344
    s_lshl_b32 s51, s23, s54
    s_add_u32 m0, s57, 16384
    v_mfma_f32_16x16x32_bf16 v[32:35], v[128:131], v[100:103], v[32:35]
    buffer_load_dwordx4 v148, s[32:35], s51 offen lds
    ds_read_b64_tr_b16 v[98:99], v144 offset:57856
    v_mfma_f32_16x16x32_bf16 v[36:39], v[128:131], v[104:107], v[36:39]
    v_mfma_f32_16x16x32_bf16 v[40:43], v[128:131], v[108:111], v[40:43]
    v_mfma_f32_16x16x32_bf16 v[44:47], v[128:131], v[112:115], v[44:47]
    v_mfma_f32_16x16x32_bf16 v[60:63], v[124:127], v[132:135], v[60:63]
    s_waitcnt lgkmcnt(0)
    v_mfma_f32_16x16x32_bf16 v[0:3], v[88:91], v[68:71], v[0:3]
    ds_read_b128 v[100:103], v137 offset:40960
    s_lshl_b32 s52, s23, s55
    s_add_u32 m0, s57, 24576
    v_mfma_f32_16x16x32_bf16 v[4:7], v[88:91], v[72:75], v[4:7]
    buffer_load_dwordx4 v149, s[36:39], s52 offen lds
    ds_read_b128 v[104:107], v137 offset:43008
    v_mfma_f32_16x16x32_bf16 v[8:11], v[88:91], v[76:79], v[8:11]
    ds_read_b128 v[108:111], v137 offset:45056
    v_mfma_f32_16x16x32_bf16 v[12:15], v[88:91], v[80:83], v[12:15]
    ds_read_b128 v[112:115], v137 offset:47104
    v_mfma_f32_16x16x32_bf16 v[48:51], v[132:135], v[84:87], v[48:51]
    ds_read_b128 v[116:119], v141 offset:40960
    v_mfma_f32_16x16x32_bf16 v[16:19], v[92:95], v[68:71], v[16:19]
    ds_read_b64_tr_b16 v[120:121], v144 offset:45056
    v_mfma_f32_16x16x32_bf16 v[20:23], v[92:95], v[72:75], v[20:23]
    ds_read_b64_tr_b16 v[122:123], v144 offset:45568
    v_mfma_f32_16x16x32_bf16 v[24:27], v[92:95], v[76:79], v[24:27]
    ds_read_b64_tr_b16 v[124:125], v144 offset:53248
    s_lshl_b32 s53, s23, s56
    s_add_u32 m0, s57, 32768
    v_mfma_f32_16x16x32_bf16 v[28:31], v[92:95], v[80:83], v[28:31]
    buffer_load_dwordx4 v150, s[40:43], s53 offen lds
    s_add_u32 s23, s23, 1
    s_and_b32 s23, s23, 7
    s_lshl_b32 s50, s23, 7
    ds_read_b64_tr_b16 v[126:127], v144 offset:53760
    v_mfma_f32_16x16x32_bf16 v[52:55], v[84:87], v[84:87], v[52:55]
    ds_read_b64_tr_b16 v[128:129], v144 offset:61440
    v_mfma_f32_16x16x32_bf16 v[32:35], v[96:99], v[68:71], v[32:35]
    ds_read_b64_tr_b16 v[130:131], v144 offset:61952
    v_mfma_f32_16x16x32_bf16 v[36:39], v[96:99], v[72:75], v[36:39]
    v_mfma_f32_16x16x32_bf16 v[40:43], v[96:99], v[76:79], v[40:43]
    v_mfma_f32_16x16x32_bf16 v[44:47], v[96:99], v[80:83], v[44:47]
    v_mfma_f32_16x16x32_bf16 v[56:59], v[88:91], v[132:135], v[56:59]
    v_mfma_f32_16x16x32_bf16 v[64:67], v[96:99], v[132:135], v[64:67]
    s_waitcnt vmcnt(5) lgkmcnt(0)
    s_barrier
    v_mfma_f32_16x16x32_bf16 v[0:3], v[120:123], v[100:103], v[0:3]
    ds_read_b128 v[68:71], v138 offset:0
    s_lshl_b32 s20, s57, 1
    s_add_u32 m0, s20, 40960
    v_mfma_f32_16x16x32_bf16 v[4:7], v[120:123], v[104:107], v[4:7]
    buffer_load_dwordx4 v146, s[24:27], s50 offen nt lds
    ds_read_b128 v[72:75], v138 offset:2048
    v_mfma_f32_16x16x32_bf16 v[8:11], v[120:123], v[108:111], v[8:11]
    ds_read_b128 v[76:79], v138 offset:4096
    v_mfma_f32_16x16x32_bf16 v[12:15], v[120:123], v[112:115], v[12:15]
    ds_read_b128 v[80:83], v138 offset:6144
    v_mfma_f32_16x16x32_bf16 v[48:51], v[132:135], v[116:119], v[48:51]
    ds_read_b128 v[84:87], v142 offset:0
    s_add_u32 m0, m0, 1024
    v_mfma_f32_16x16x32_bf16 v[16:19], v[124:127], v[100:103], v[16:19]
    buffer_load_dwordx4 v147, s[24:27], s50 offen nt lds
    ds_read_b64_tr_b16 v[88:89], v145 offset:0
    v_mfma_f32_16x16x32_bf16 v[20:23], v[124:127], v[104:107], v[20:23]
    ds_read_b64_tr_b16 v[90:91], v145 offset:512
    v_mfma_f32_16x16x32_bf16 v[24:27], v[124:127], v[108:111], v[24:27]
    ds_read_b64_tr_b16 v[92:93], v145 offset:8192
    v_mfma_f32_16x16x32_bf16 v[28:31], v[124:127], v[112:115], v[28:31]
    ds_read_b64_tr_b16 v[94:95], v145 offset:8704
    v_mfma_f32_16x16x32_bf16 v[52:55], v[116:119], v[116:119], v[52:55]
    ds_read_b64_tr_b16 v[96:97], v145 offset:16384
    s_lshl_b32 s51, s23, s54
    s_add_u32 m0, s57, 57344
    v_mfma_f32_16x16x32_bf16 v[32:35], v[128:131], v[100:103], v[32:35]
    buffer_load_dwordx4 v148, s[32:35], s51 offen lds
    ds_read_b64_tr_b16 v[98:99], v145 offset:16896
    v_mfma_f32_16x16x32_bf16 v[36:39], v[128:131], v[104:107], v[36:39]
    v_mfma_f32_16x16x32_bf16 v[40:43], v[128:131], v[108:111], v[40:43]
    v_mfma_f32_16x16x32_bf16 v[44:47], v[128:131], v[112:115], v[44:47]
    v_mfma_f32_16x16x32_bf16 v[60:63], v[124:127], v[132:135], v[60:63]
    s_waitcnt lgkmcnt(0)
    v_mfma_f32_16x16x32_bf16 v[0:3], v[88:91], v[68:71], v[0:3]
    ds_read_b128 v[100:103], v139 offset:0
    s_lshl_b32 s52, s23, s55
    s_add_u32 m0, s57, 65536
    v_mfma_f32_16x16x32_bf16 v[4:7], v[88:91], v[72:75], v[4:7]
    buffer_load_dwordx4 v149, s[36:39], s52 offen lds
    ds_read_b128 v[104:107], v139 offset:2048
    v_mfma_f32_16x16x32_bf16 v[8:11], v[88:91], v[76:79], v[8:11]
    ds_read_b128 v[108:111], v139 offset:4096
    v_mfma_f32_16x16x32_bf16 v[12:15], v[88:91], v[80:83], v[12:15]
    ds_read_b128 v[112:115], v139 offset:6144
    v_mfma_f32_16x16x32_bf16 v[48:51], v[132:135], v[84:87], v[48:51]
    ds_read_b128 v[116:119], v143 offset:0
    v_mfma_f32_16x16x32_bf16 v[16:19], v[92:95], v[68:71], v[16:19]
    ds_read_b64_tr_b16 v[120:121], v145 offset:4096
    v_mfma_f32_16x16x32_bf16 v[20:23], v[92:95], v[72:75], v[20:23]
    ds_read_b64_tr_b16 v[122:123], v145 offset:4608
    v_mfma_f32_16x16x32_bf16 v[24:27], v[92:95], v[76:79], v[24:27]
    ds_read_b64_tr_b16 v[124:125], v145 offset:12288
    s_lshl_b32 s53, s23, s56
    s_add_u32 m0, s57, 73728
    v_mfma_f32_16x16x32_bf16 v[28:31], v[92:95], v[80:83], v[28:31]
    buffer_load_dwordx4 v150, s[40:43], s53 offen lds
    s_add_u32 s23, s23, 1
    s_and_b32 s23, s23, 7
    s_lshl_b32 s50, s23, 7
    ds_read_b64_tr_b16 v[126:127], v145 offset:12800
    v_mfma_f32_16x16x32_bf16 v[52:55], v[84:87], v[84:87], v[52:55]
    ds_read_b64_tr_b16 v[128:129], v145 offset:20480
    v_mfma_f32_16x16x32_bf16 v[32:35], v[96:99], v[68:71], v[32:35]
    ds_read_b64_tr_b16 v[130:131], v145 offset:20992
    v_mfma_f32_16x16x32_bf16 v[36:39], v[96:99], v[72:75], v[36:39]
    v_mfma_f32_16x16x32_bf16 v[40:43], v[96:99], v[76:79], v[40:43]
    v_mfma_f32_16x16x32_bf16 v[44:47], v[96:99], v[80:83], v[44:47]
    v_mfma_f32_16x16x32_bf16 v[56:59], v[88:91], v[132:135], v[56:59]
    v_mfma_f32_16x16x32_bf16 v[64:67], v[96:99], v[132:135], v[64:67]
    s_waitcnt vmcnt(5) lgkmcnt(0)
    s_barrier
    v_mfma_f32_16x16x32_bf16 v[0:3], v[120:123], v[100:103], v[0:3]
    ds_read_b128 v[68:71], v136 offset:0
    v_mfma_f32_16x16x32_bf16 v[4:7], v[120:123], v[104:107], v[4:7]
    ds_read_b128 v[72:75], v136 offset:2048
    v_mfma_f32_16x16x32_bf16 v[8:11], v[120:123], v[108:111], v[8:11]
    ds_read_b128 v[76:79], v136 offset:4096
    v_mfma_f32_16x16x32_bf16 v[12:15], v[120:123], v[112:115], v[12:15]
    ds_read_b128 v[80:83], v136 offset:6144
    v_mfma_f32_16x16x32_bf16 v[48:51], v[132:135], v[116:119], v[48:51]
    ds_read_b128 v[84:87], v140 offset:0
    v_mfma_f32_16x16x32_bf16 v[16:19], v[124:127], v[100:103], v[16:19]
    ds_read_b64_tr_b16 v[88:89], v144 offset:0
    v_mfma_f32_16x16x32_bf16 v[20:23], v[124:127], v[104:107], v[20:23]
    ds_read_b64_tr_b16 v[90:91], v144 offset:512
    v_mfma_f32_16x16x32_bf16 v[24:27], v[124:127], v[108:111], v[24:27]
    ds_read_b64_tr_b16 v[92:93], v144 offset:8192
    v_mfma_f32_16x16x32_bf16 v[28:31], v[124:127], v[112:115], v[28:31]
    ds_read_b64_tr_b16 v[94:95], v144 offset:8704
    v_mfma_f32_16x16x32_bf16 v[52:55], v[116:119], v[116:119], v[52:55]
    ds_read_b64_tr_b16 v[96:97], v144 offset:16384
    v_mfma_f32_16x16x32_bf16 v[32:35], v[128:131], v[100:103], v[32:35]
    ds_read_b64_tr_b16 v[98:99], v144 offset:16896
    v_mfma_f32_16x16x32_bf16 v[36:39], v[128:131], v[104:107], v[36:39]
    v_mfma_f32_16x16x32_bf16 v[40:43], v[128:131], v[108:111], v[40:43]
    v_mfma_f32_16x16x32_bf16 v[44:47], v[128:131], v[112:115], v[44:47]
    v_mfma_f32_16x16x32_bf16 v[60:63], v[124:127], v[132:135], v[60:63]
    s_waitcnt lgkmcnt(0)
    v_mfma_f32_16x16x32_bf16 v[0:3], v[88:91], v[68:71], v[0:3]
    ds_read_b128 v[100:103], v137 offset:0
    v_mfma_f32_16x16x32_bf16 v[4:7], v[88:91], v[72:75], v[4:7]
    ds_read_b128 v[104:107], v137 offset:2048
    v_mfma_f32_16x16x32_bf16 v[8:11], v[88:91], v[76:79], v[8:11]
    ds_read_b128 v[108:111], v137 offset:4096
    v_mfma_f32_16x16x32_bf16 v[12:15], v[88:91], v[80:83], v[12:15]
    ds_read_b128 v[112:115], v137 offset:6144
    v_mfma_f32_16x16x32_bf16 v[48:51], v[132:135], v[84:87], v[48:51]
    ds_read_b128 v[116:119], v141 offset:0
    v_mfma_f32_16x16x32_bf16 v[16:19], v[92:95], v[68:71], v[16:19]
    ds_read_b64_tr_b16 v[120:121], v144 offset:4096
    v_mfma_f32_16x16x32_bf16 v[20:23], v[92:95], v[72:75], v[20:23]
    ds_read_b64_tr_b16 v[122:123], v144 offset:4608
    v_mfma_f32_16x16x32_bf16 v[24:27], v[92:95], v[76:79], v[24:27]
    ds_read_b64_tr_b16 v[124:125], v144 offset:12288
    v_mfma_f32_16x16x32_bf16 v[28:31], v[92:95], v[80:83], v[28:31]
    ds_read_b64_tr_b16 v[126:127], v144 offset:12800
    v_mfma_f32_16x16x32_bf16 v[52:55], v[84:87], v[84:87], v[52:55]
    ds_read_b64_tr_b16 v[128:129], v144 offset:20480
    v_mfma_f32_16x16x32_bf16 v[32:35], v[96:99], v[68:71], v[32:35]
    ds_read_b64_tr_b16 v[130:131], v144 offset:20992
    v_mfma_f32_16x16x32_bf16 v[36:39], v[96:99], v[72:75], v[36:39]
    v_mfma_f32_16x16x32_bf16 v[40:43], v[96:99], v[76:79], v[40:43]
    v_mfma_f32_16x16x32_bf16 v[44:47], v[96:99], v[80:83], v[44:47]
    v_mfma_f32_16x16x32_bf16 v[56:59], v[88:91], v[132:135], v[56:59]
    v_mfma_f32_16x16x32_bf16 v[64:67], v[96:99], v[132:135], v[64:67]
    s_waitcnt vmcnt(0) lgkmcnt(0)
    s_barrier
    v_mfma_f32_16x16x32_bf16 v[0:3], v[120:123], v[100:103], v[0:3]
    ds_read_b128 v[68:71], v136 offset:40960
    v_mfma_f32_16x16x32_bf16 v[4:7], v[120:123], v[104:107], v[4:7]
    ds_read_b128 v[72:75], v136 offset:43008
    v_mfma_f32_16x16x32_bf16 v[8:11], v[120:123], v[108:111], v[8:11]
    ds_read_b128 v[76:79], v136 offset:45056
    v_mfma_f32_16x16x32_bf16 v[12:15], v[120:123], v[112:115], v[12:15]
    ds_read_b128 v[80:83], v136 offset:47104
    v_mfma_f32_16x16x32_bf16 v[48:51], v[132:135], v[116:119], v[48:51]
    ds_read_b128 v[84:87], v140 offset:40960
    v_mfma_f32_16x16x32_bf16 v[16:19], v[124:127], v[100:103], v[16:19]
    ds_read_b64_tr_b16 v[88:89], v144 offset:40960
    v_mfma_f32_16x16x32_bf16 v[20:23], v[124:127], v[104:107], v[20:23]
    ds_read_b64_tr_b16 v[90:91], v144 offset:41472
    v_mfma_f32_16x16x32_bf16 v[24:27], v[124:127], v[108:111], v[24:27]
    ds_read_b64_tr_b16 v[92:93], v144 offset:49152
    v_mfma_f32_16x16x32_bf16 v[28:31], v[124:127], v[112:115], v[28:31]
    ds_read_b64_tr_b16 v[94:95], v144 offset:49664
    v_mfma_f32_16x16x32_bf16 v[52:55], v[116:119], v[116:119], v[52:55]
    ds_read_b64_tr_b16 v[96:97], v144 offset:57344
    v_mfma_f32_16x16x32_bf16 v[32:35], v[128:131], v[100:103], v[32:35]
    ds_read_b64_tr_b16 v[98:99], v144 offset:57856
    v_mfma_f32_16x16x32_bf16 v[36:39], v[128:131], v[104:107], v[36:39]
    v_mfma_f32_16x16x32_bf16 v[40:43], v[128:131], v[108:111], v[40:43]
    v_mfma_f32_16x16x32_bf16 v[44:47], v[128:131], v[112:115], v[44:47]
    v_mfma_f32_16x16x32_bf16 v[60:63], v[124:127], v[132:135], v[60:63]
    s_waitcnt lgkmcnt(0)
    v_mfma_f32_16x16x32_bf16 v[0:3], v[88:91], v[68:71], v[0:3]
    ds_read_b128 v[100:103], v137 offset:40960
    v_mfma_f32_16x16x32_bf16 v[4:7], v[88:91], v[72:75], v[4:7]
    ds_read_b128 v[104:107], v137 offset:43008
    v_mfma_f32_16x16x32_bf16 v[8:11], v[88:91], v[76:79], v[8:11]
    ds_read_b128 v[108:111], v137 offset:45056
    v_mfma_f32_16x16x32_bf16 v[12:15], v[88:91], v[80:83], v[12:15]
    ds_read_b128 v[112:115], v137 offset:47104
    v_mfma_f32_16x16x32_bf16 v[48:51], v[132:135], v[84:87], v[48:51]
    ds_read_b128 v[116:119], v141 offset:40960
    v_mfma_f32_16x16x32_bf16 v[16:19], v[92:95], v[68:71], v[16:19]
    ds_read_b64_tr_b16 v[120:121], v144 offset:45056
    v_mfma_f32_16x16x32_bf16 v[20:23], v[92:95], v[72:75], v[20:23]
    ds_read_b64_tr_b16 v[122:123], v144 offset:45568
    v_mfma_f32_16x16x32_bf16 v[24:27], v[92:95], v[76:79], v[24:27]
    ds_read_b64_tr_b16 v[124:125], v144 offset:53248
    v_mfma_f32_16x16x32_bf16 v[28:31], v[92:95], v[80:83], v[28:31]
    ds_read_b64_tr_b16 v[126:127], v144 offset:53760
    v_mfma_f32_16x16x32_bf16 v[52:55], v[84:87], v[84:87], v[52:55]
    ds_read_b64_tr_b16 v[128:129], v144 offset:61440
    v_mfma_f32_16x16x32_bf16 v[32:35], v[96:99], v[68:71], v[32:35]
    ds_read_b64_tr_b16 v[130:131], v144 offset:61952
    v_mfma_f32_16x16x32_bf16 v[36:39], v[96:99], v[72:75], v[36:39]
    v_mfma_f32_16x16x32_bf16 v[40:43], v[96:99], v[76:79], v[40:43]
    v_mfma_f32_16x16x32_bf16 v[44:47], v[96:99], v[80:83], v[44:47]
    v_mfma_f32_16x16x32_bf16 v[56:59], v[88:91], v[132:135], v[56:59]
    v_mfma_f32_16x16x32_bf16 v[64:67], v[96:99], v[132:135], v[64:67]
    s_waitcnt lgkmcnt(0)
    v_mfma_f32_16x16x32_bf16 v[48:51], v[132:135], v[116:119], v[48:51]
    v_mfma_f32_16x16x32_bf16 v[52:55], v[116:119], v[116:119], v[52:55]
    v_mfma_f32_16x16x32_bf16 v[60:63], v[124:127], v[132:135], v[60:63]
    v_mfma_f32_16x16x32_bf16 v[0:3], v[120:123], v[100:103], v[0:3]
    v_mfma_f32_16x16x32_bf16 v[4:7], v[120:123], v[104:107], v[4:7]
    v_mfma_f32_16x16x32_bf16 v[8:11], v[120:123], v[108:111], v[8:11]
    v_cmp_eq_u32 vcc, 1, v166
    s_nop 2
    v_cndmask_b32 v68, v52, v53, vcc
    v_mfma_f32_16x16x32_bf16 v[12:15], v[120:123], v[112:115], v[12:15]
    v_cmp_eq_u32 vcc, 2, v166
    s_nop 1
    v_cndmask_b32 v68, v68, v54, vcc
    v_mfma_f32_16x16x32_bf16 v[16:19], v[124:127], v[100:103], v[16:19]
    v_cmp_eq_u32 vcc, 3, v166
    s_nop 1
    v_cndmask_b32 v68, v68, v55, vcc
    v_mfma_f32_16x16x32_bf16 v[20:23], v[124:127], v[104:107], v[20:23]
    s_mov_b32 s21, 0x3b000000
    v_mul_f32 v70, s21, v48
    v_mul_f32 v68, s21, v68
    v_mfma_f32_16x16x32_bf16 v[24:27], v[124:127], v[108:111], v[24:27]
    v_fma_f32 v71, -v70, v70, v68
    s_mov_b32 s21, 0x3727c5ac
    v_mfma_f32_16x16x32_bf16 v[28:31], v[124:127], v[112:115], v[28:31]
    v_max_f32 v71, 0, v71
    v_add_f32 v71, s21, v71
    v_mfma_f32_16x16x32_bf16 v[32:35], v[128:131], v[100:103], v[32:35]
    v_rsq_f32 v71, v71
    v_sub_f32 v70, 0, v70
    v_mfma_f32_16x16x32_bf16 v[36:39], v[128:131], v[104:107], v[36:39]
    s_mov_b64 exec, s[96:97]
    ds_write_b128 v159, v[56:59] offset:1024
    ds_write_b128 v159, v[60:63] offset:1088
    ds_write_b128 v159, v[64:67] offset:1152
    s_mov_b64 exec, -1
    v_mfma_f32_16x16x32_bf16 v[40:43], v[128:131], v[108:111], v[40:43]
    s_mov_b64 exec, s[94:95]
    ds_write_b64 v158, v[70:71] offset:0
    s_mov_b64 exec, -1
    v_mfma_f32_16x16x32_bf16 v[44:47], v[128:131], v[112:115], v[44:47]
    s_branch K1EPI_8
K1V_6:
    ds_read_b128 v[68:71], v136 offset:0
    ds_read_b128 v[72:75], v136 offset:2048
    ds_read_b128 v[76:79], v136 offset:4096
    ds_read_b128 v[80:83], v136 offset:6144
    ds_read_b128 v[84:87], v140 offset:0
    ds_read_b64_tr_b16 v[88:89], v144 offset:0
    ds_read_b64_tr_b16 v[90:91], v144 offset:512
    ds_read_b64_tr_b16 v[92:93], v144 offset:8192
    ds_read_b64_tr_b16 v[94:95], v144 offset:8704
    ds_read_b64_tr_b16 v[96:97], v144 offset:16384
    ds_read_b64_tr_b16 v[98:99], v144 offset:16896
    s_waitcnt lgkmcnt(0)
    v_mfma_f32_16x16x32_bf16 v[0:3], v[88:91], v[68:71], 0
    ds_read_b128 v[100:103], v137 offset:0
    s_lshl_b32 s20, s57, 1
    s_add_u32 m0, s20, 81920
    v_mfma_f32_16x16x32_bf16 v[4:7], v[88:91], v[72:75], 0
    buffer_load_dwordx4 v146, s[24:27], s50 offen nt lds
    ds_read_b128 v[104:107], v137 offset:2048
    v_mfma_f32_16x16x32_bf16 v[8:11], v[88:91], v[76:79], 0
    ds_read_b128 v[108:111], v137 offset:4096
    s_add_u32 m0, m0, 1024
    v_mfma_f32_16x16x32_bf16 v[12:15], v[88:91], v[80:83], 0
    buffer_load_dwordx4 v147, s[24:27], s50 offen nt lds
    ds_read_b128 v[112:115], v137 offset:6144
    v_mfma_f32_16x16x32_bf16 v[48:51], v[132:135], v[84:87], 0
    ds_read_b128 v[116:119], v141 offset:0
    v_mfma_f32_16x16x32_bf16 v[16:19], v[92:95], v[68:71], 0
    ds_read_b64_tr_b16 v[120:121], v144 offset:4096
    s_lshl_b32 s51, s23, s54
    s_add_u32 m0, s57, 98304
    v_mfma_f32_16x16x32_bf16 v[20:23], v[92:95], v[72:75], 0
    buffer_load_dwordx4 v148, s[32:35], s51 offen lds
    ds_read_b64_tr_b16 v[122:123], v144 offset:4608
    v_mfma_f32_16x16x32_bf16 v[24:27], v[92:95], v[76:79], 0
    ds_read_b64_tr_b16 v[124:125], v144 offset:12288
    v_mfma_f32_16x16x32_bf16 v[28:31], v[92:95], v[80:83], 0
    ds_read_b64_tr_b16 v[126:127], v144 offset:12800
    s_lshl_b32 s52, s23, s55
    s_add_u32 m0, s57, 106496
    v_mfma_f32_16x16x32_bf16 v[52:55], v[84:87], v[84:87], 0
    buffer_load_dwordx4 v149, s[36:39], s52 offen lds
    ds_read_b64_tr_b16 v[128:129], v144 offset:20480
    v_mfma_f32_16x16x32_bf16 v[32:35], v[96:99], v[68:71], 0
    ds_read_b64_tr_b16 v[130:131], v144 offset:20992
    v_mfma_f32_16x16x32_bf16 v[36:39], v[96:99], v[72:75], 0
    s_lshl_b32 s53, s23, s56
    s_add_u32 m0, s57, 114688
    v_mfma_f32_16x16x32_bf16 v[40:43], v[96:99], v[76:79], 0
    buffer_load_dwordx4 v150, s[40:43], s53 offen lds
    s_add_u32 s23, s23, 1
    s_and_b32 s23, s23, 7
    s_lshl_b32 s50, s23, 7
    v_mfma_f32_16x16x32_bf16 v[44:47], v[96:99], v[80:83], 0
    v_mfma_f32_16x16x32_bf16 v[60:63], v[92:95], v[132:135], v[60:63]
    s_waitcnt vmcnt(5) lgkmcnt(0)
    s_barrier
    v_mfma_f32_16x16x32_bf16 v[0:3], v[120:123], v[100:103], v[0:3]
    ds_read_b128 v[68:71], v136 offset:40960
    s_lshl_b32 s20, s57, 1
    s_add_u32 m0, s20, 0
    v_mfma_f32_16x16x32_bf16 v[4:7], v[120:123], v[104:107], v[4:7]
    buffer_load_dwordx4 v146, s[24:27], s50 offen nt lds
    ds_read_b128 v[72:75], v136 offset:43008
    v_mfma_f32_16x16x32_bf16 v[8:11], v[120:123], v[108:111], v[8:11]
    ds_read_b128 v[76:79], v136 offset:45056
    v_mfma_f32_16x16x32_bf16 v[12:15], v[120:123], v[112:115], v[12:15]
    ds_read_b128 v[80:83], v136 offset:47104
    v_mfma_f32_16x16x32_bf16 v[48:51], v[132:135], v[116:119], v[48:51]
    ds_read_b128 v[84:87], v140 offset:40960
    v_mfma_f32_16x16x32_bf16 v[16:19], v[124:127], v[100:103], v[16:19]
    ds_read_b64_tr_b16 v[88:89], v144 offset:40960
    s_add_u32 m0, m0, 1024
    v_mfma_f32_16x16x32_bf16 v[20:23], v[124:127], v[104:107], v[20:23]
    buffer_load_dwordx4 v147, s[24:27], s50 offen nt lds
    ds_read_b64_tr_b16 v[90:91], v144 offset:41472
    v_mfma_f32_16x16x32_bf16 v[24:27], v[124:127], v[108:111], v[24:27]
    ds_read_b64_tr_b16 v[92:93], v144 offset:49152
    v_mfma_f32_16x16x32_bf16 v[28:31], v[124:127], v[112:115], v[28:31]
    ds_read_b64_tr_b16 v[94:95], v144 offset:49664
    v_mfma_f32_16x16x32_bf16 v[52:55], v[116:119], v[116:119], v[52:55]
    ds_read_b64_tr_b16 v[96:97], v144 offset:57344
    v_mfma_f32_16x16x32_bf16 v[32:35], v[128:131], v[100:103], v[32:35]
    ds_read_b64_tr_b16 v[98:99], v144 offset:57856
    s_lshl_b32 s51, s23, s54
    s_add_u32 m0, s57, 16384
    v_mfma_f32_16x16x32_bf16 v[36:39], v[128:131], v[104:107], v[36:39]
    buffer_load_dwordx4 v148, s[32:35], s51 offen lds
    v_mfma_f32_16x16x32_bf16 v[40:43], v[128:131], v[108:111], v[40:43]
    v_mfma_f32_16x16x32_bf16 v[44:47], v[128:131], v[112:115], v[44:47]
    v_mfma_f32_16x16x32_bf16 v[56:59], v[120:123], v[132:135], v[56:59]
    v_mfma_f32_16x16x32_bf16 v[64:67], v[128:131], v[132:135], v[64:67]
    s_waitcnt lgkmcnt(0)
    v_mfma_f32_16x16x32_bf16 v[0:3], v[88:91], v[68:71], v[0:3]
    ds_read_b128 v[100:103], v137 offset:40960
    s_lshl_b32 s52, s23, s55
    s_add_u32 m0, s57, 24576
    v_mfma_f32_16x16x32_bf16 v[4:7], v[88:91], v[72:75], v[4:7]
    buffer_load_dwordx4 v149, s[36:39], s52 offen lds
    ds_read_b128 v[104:107], v137 offset:43008
    v_mfma_f32_16x16x32_bf16 v[8:11], v[88:91], v[76:79], v[8:11]
    ds_read_b128 v[108:111], v137 offset:45056
    v_mfma_f32_16x16x32_bf16 v[12:15], v[88:91], v[80:83], v[12:15]
    ds_read_b128 v[112:115], v137 offset:47104
    v_mfma_f32_16x16x32_bf16 v[48:51], v[132:135], v[84:87], v[48:51]
    ds_read_b128 v[116:119], v141 offset:40960
    v_mfma_f32_16x16x32_bf16 v[16:19], v[92:95], v[68:71], v[16:19]
    ds_read_b64_tr_b16 v[120:121], v144 offset:45056
    v_mfma_f32_16x16x32_bf16 v[20:23], v[92:95], v[72:75], v[20:23]
    ds_read_b64_tr_b16 v[122:123], v144 offset:45568
    v_mfma_f32_16x16x32_bf16 v[24:27], v[92:95], v[76:79], v[24:27]
    ds_read_b64_tr_b16 v[124:125], v144 offset:53248
    s_lshl_b32 s53, s23, s56
    s_add_u32 m0, s57, 32768
    v_mfma_f32_16x16x32_bf16 v[28:31], v[92:95], v[80:83], v[28:31]
    buffer_load_dwordx4 v150, s[40:43], s53 offen lds
    s_add_u32 s23, s23, 1
    s_and_b32 s23, s23, 7
    s_lshl_b32 s50, s23, 7
    ds_read_b64_tr_b16 v[126:127], v144 offset:53760
    v_mfma_f32_16x16x32_bf16 v[52:55], v[84:87], v[84:87], v[52:55]
    ds_read_b64_tr_b16 v[128:129], v144 offset:61440
    v_mfma_f32_16x16x32_bf16 v[32:35], v[96:99], v[68:71], v[32:35]
    ds_read_b64_tr_b16 v[130:131], v144 offset:61952
    v_mfma_f32_16x16x32_bf16 v[36:39], v[96:99], v[72:75], v[36:39]
    v_mfma_f32_16x16x32_bf16 v[40:43], v[96:99], v[76:79], v[40:43]
    v_mfma_f32_16x16x32_bf16 v[44:47], v[96:99], v[80:83], v[44:47]
    v_mfma_f32_16x16x32_bf16 v[60:63], v[92:95], v[132:135], v[60:63]
    s_waitcnt vmcnt(5) lgkmcnt(0)
    s_barrier
    v_mfma_f32_16x16x32_bf16 v[0:3], v[120:123], v[100:103], v[0:3]
    ds_read_b128 v[68:71], v138 offset:0
    s_lshl_b32 s20, s57, 1
    s_add_u32 m0, s20, 40960
    v_mfma_f32_16x16x32_bf16 v[4:7], v[120:123], v[104:107], v[4:7]
    buffer_load_dwordx4 v146, s[24:27], s50 offen nt lds
    ds_read_b128 v[72:75], v138 offset:2048
    v_mfma_f32_16x16x32_bf16 v[8:11], v[120:123], v[108:111], v[8:11]
    ds_read_b128 v[76:79], v138 offset:4096
    v_mfma_f32_16x16x32_bf16 v[12:15], v[120:123], v[112:115], v[12:15]
    ds_read_b128 v[80:83], v138 offset:6144
    v_mfma_f32_16x16x32_bf16 v[48:51], v[132:135], v[116:119], v[48:51]
    ds_read_b128 v[84:87], v142 offset:0
    v_mfma_f32_16x16x32_bf16 v[16:19], v[124:127], v[100:103], v[16:19]
    ds_read_b64_tr_b16 v[88:89], v145 offset:0
    s_add_u32 m0, m0, 1024
    v_mfma_f32_16x16x32_bf16 v[20:23], v[124:127], v[104:107], v[20:23]
    buffer_load_dwordx4 v147, s[24:27], s50 offen nt lds
    ds_read_b64_tr_b16 v[90:91], v145 offset:512
    v_mfma_f32_16x16x32_bf16 v[24:27], v[124:127], v[108:111], v[24:27]
    ds_read_b64_tr_b16 v[92:93], v145 offset:8192
    v_mfma_f32_16x16x32_bf16 v[28:31], v[124:127], v[112:115], v[28:31]
    ds_read_b64_tr_b16 v[94:95], v145 offset:8704
    v_mfma_f32_16x16x32_bf16 v[52:55], v[116:119], v[116:119], v[52:55]
    ds_read_b64_tr_b16 v[96:97], v145 offset:16384
    v_mfma_f32_16x16x32_bf16 v[32:35], v[128:131], v[100:103], v[32:35]
    ds_read_b64_tr_b16 v[98:99], v145 offset:16896
    s_lshl_b32 s51, s23, s54
    s_add_u32 m0, s57, 57344
    v_mfma_f32_16x16x32_bf16 v[36:39], v[128:131], v[104:107], v[36:39]
    buffer_load_dwordx4 v148, s[32:35], s51 offen lds
    v_mfma_f32_16x16x32_bf16 v[40:43], v[128:131], v[108:111], v[40:43]
    v_mfma_f32_16x16x32_bf16 v[44:47], v[128:131], v[112:115], v[44:47]
    v_mfma_f32_16x16x32_bf16 v[56:59], v[120:123], v[132:135], v[56:59]
    v_mfma_f32_16x16x32_bf16 v[64:67], v[128:131], v[132:135], v[64:67]
    s_waitcnt lgkmcnt(0)
    v_mfma_f32_16x16x32_bf16 v[0:3], v[88:91], v[68:71], v[0:3]
    ds_read_b128 v[100:103], v139 offset:0
    s_lshl_b32 s52, s23, s55
    s_add_u32 m0, s57, 65536
    v_mfma_f32_16x16x32_bf16 v[4:7], v[88:91], v[72:75], v[4:7]
    buffer_load_dwordx4 v149, s[36:39], s52 offen lds
    ds_read_b128 v[104:107], v139 offset:2048
    v_mfma_f32_16x16x32_bf16 v[8:11], v[88:91], v[76:79], v[8:11]
    ds_read_b128 v[108:111], v139 offset:4096
    v_mfma_f32_16x16x32_bf16 v[12:15], v[88:91], v[80:83], v[12:15]
    ds_read_b128 v[112:115], v139 offset:6144
    v_mfma_f32_16x16x32_bf16 v[48:51], v[132:135], v[84:87], v[48:51]
    ds_read_b128 v[116:119], v143 offset:0
    v_mfma_f32_16x16x32_bf16 v[16:19], v[92:95], v[68:71], v[16:19]
    ds_read_b64_tr_b16 v[120:121], v145 offset:4096
    v_mfma_f32_16x16x32_bf16 v[20:23], v[92:95], v[72:75], v[20:23]
    ds_read_b64_tr_b16 v[122:123], v145 offset:4608
    v_mfma_f32_16x16x32_bf16 v[24:27], v[92:95], v[76:79], v[24:27]
    ds_read_b64_tr_b16 v[124:125], v145 offset:12288
    s_lshl_b32 s53, s23, s56
    s_add_u32 m0, s57, 73728
    v_mfma_f32_16x16x32_bf16 v[28:31], v[92:95], v[80:83], v[28:31]
    buffer_load_dwordx4 v150, s[40:43], s53 offen lds
    s_add_u32 s23, s23, 1
    s_and_b32 s23, s23, 7
    s_lshl_b32 s50, s23, 7
    ds_read_b64_tr_b16 v[126:127], v145 offset:12800
    v_mfma_f32_16x16x32_bf16 v[52:55], v[84:87], v[84:87], v[52:55]
    ds_read_b64_tr_b16 v[128:129], v145 offset:20480
    v_mfma_f32_16x16x32_bf16 v[32:35], v[96:99], v[68:71], v[32:35]
    ds_read_b64_tr_b16 v[130:131], v145 offset:20992
    v_mfma_f32_16x16x32_bf16 v[36:39], v[96:99], v[72:75], v[36:39]
    v_mfma_f32_16x16x32_bf16 v[40:43], v[96:99], v[76:79], v[40:43]
    v_mfma_f32_16x16x32_bf16 v[44:47], v[96:99], v[80:83], v[44:47]
    v_mfma_f32_16x16x32_bf16 v[60:63], v[92:95], v[132:135], v[60:63]
    s_waitcnt vmcnt(5) lgkmcnt(0)
    s_barrier
    v_mfma_f32_16x16x32_bf16 v[0:3], v[120:123], v[100:103], v[0:3]
    ds_read_b128 v[68:71], v136 offset:0
    s_lshl_b32 s20, s57, 1
    s_add_u32 m0, s20, 81920
    v_mfma_f32_16x16x32_bf16 v[4:7], v[120:123], v[104:107], v[4:7]
    buffer_load_dwordx4 v146, s[24:27], s50 offen nt lds
    ds_read_b128 v[72:75], v136 offset:2048
    v_mfma_f32_16x16x32_bf16 v[8:11], v[120:123], v[108:111], v[8:11]
    ds_read_b128 v[76:79], v136 offset:4096
    v_mfma_f32_16x16x32_bf16 v[12:15], v[120:123], v[112:115], v[12:15]
    ds_read_b128 v[80:83], v136 offset:6144
    v_mfma_f32_16x16x32_bf16 v[48:51], v[132:135], v[116:119], v[48:51]
    ds_read_b128 v[84:87], v140 offset:0
    v_mfma_f32_16x16x32_bf16 v[16:19], v[124:127], v[100:103], v[16:19]
    ds_read_b64_tr_b16 v[88:89], v144 offset:0
    s_add_u32 m0, m0, 1024
    v_mfma_f32_16x16x32_bf16 v[20:23], v[124:127], v[104:107], v[20:23]
    buffer_load_dwordx4 v147, s[24:27], s50 offen nt lds
    ds_read_b64_tr_b16 v[90:91], v144 offset:512
    v_mfma_f32_16x16x32_bf16 v[24:27], v[124:127], v[108:111], v[24:27]
    ds_read_b64_tr_b16 v[92:93], v144 offset:8192
    v_mfma_f32_16x16x32_bf16 v[28:31], v[124:127], v[112:115], v[28:31]
    ds_read_b64_tr_b16 v[94:95], v144 offset:8704
    v_mfma_f32_16x16x32_bf16 v[52:55], v[116:119], v[116:119], v[52:55]
    ds_read_b64_tr_b16 v[96:97], v144 offset:16384
    v_mfma_f32_16x16x32_bf16 v[32:35], v[128:131], v[100:103], v[32:35]
    ds_read_b64_tr_b16 v[98:99], v144 offset:16896
    s_lshl_b32 s51, s23, s54
    s_add_u32 m0, s57, 98304
    v_mfma_f32_16x16x32_bf16 v[36:39], v[128:131], v[104:107], v[36:39]
    buffer_load_dwordx4 v148, s[32:35], s51 offen lds
    v_mfma_f32_16x16x32_bf16 v[40:43], v[128:131], v[108:111], v[40:43]
    v_mfma_f32_16x16x32_bf16 v[44:47], v[128:131], v[112:115], v[44:47]
    v_mfma_f32_16x16x32_bf16 v[56:59], v[120:123], v[132:135], v[56:59]
    v_mfma_f32_16x16x32_bf16 v[64:67], v[128:131], v[132:135], v[64:67]
    s_waitcnt lgkmcnt(0)
    v_mfma_f32_16x16x32_bf16 v[0:3], v[88:91], v[68:71], v[0:3]
    ds_read_b128 v[100:103], v137 offset:0
    s_lshl_b32 s52, s23, s55
    s_add_u32 m0, s57, 106496
    v_mfma_f32_16x16x32_bf16 v[4:7], v[88:91], v[72:75], v[4:7]
    buffer_load_dwordx4 v149, s[36:39], s52 offen lds
    ds_read_b128 v[104:107], v137 offset:2048
    v_mfma_f32_16x16x32_bf16 v[8:11], v[88:91], v[76:79], v[8:11]
    ds_read_b128 v[108:111], v137 offset:4096
    v_mfma_f32_16x16x32_bf16 v[12:15], v[88:91], v[80:83], v[12:15]
    ds_read_b128 v[112:115], v137 offset:6144
    v_mfma_f32_16x16x32_bf16 v[48:51], v[132:135], v[84:87], v[48:51]
    ds_read_b128 v[116:119], v141 offset:0
    v_mfma_f32_16x16x32_bf16 v[16:19], v[92:95], v[68:71], v[16:19]
    ds_read_b64_tr_b16 v[120:121], v144 offset:4096
    v_mfma_f32_16x16x32_bf16 v[20:23], v[92:95], v[72:75], v[20:23]
    ds_read_b64_tr_b16 v[122:123], v144 offset:4608
    v_mfma_f32_16x16x32_bf16 v[24:27], v[92:95], v[76:79], v[24:27]
    ds_read_b64_tr_b16 v[124:125], v144 offset:12288
    s_lshl_b32 s53, s23, s56
    s_add_u32 m0, s57, 114688
    v_mfma_f32_16x16x32_bf16 v[28:31], v[92:95], v[80:83], v[28:31]
    buffer_load_dwordx4 v150, s[40:43], s53 offen lds
    s_add_u32 s23, s23, 1
    s_and_b32 s23, s23, 7
    s_lshl_b32 s50, s23, 7
    ds_read_b64_tr_b16 v[126:127], v144 offset:12800
    v_mfma_f32_16x16x32_bf16 v[52:55], v[84:87], v[84:87], v[52:55]
    ds_read_b64_tr_b16 v[128:129], v144 offset:20480
    v_mfma_f32_16x16x32_bf16 v[32:35], v[96:99], v[68:71], v[32:35]
    ds_read_b64_tr_b16 v[130:131], v144 offset:20992
    v_mfma_f32_16x16x32_bf16 v[36:39], v[96:99], v[72:75], v[36:39]
    v_mfma_f32_16x16x32_bf16 v[40:43], v[96:99], v[76:79], v[40:43]
    v_mfma_f32_16x16x32_bf16 v[44:47], v[96:99], v[80:83], v[44:47]
    v_mfma_f32_16x16x32_bf16 v[60:63], v[92:95], v[132:135], v[60:63]
    s_waitcnt vmcnt(5) lgkmcnt(0)
    s_barrier
    v_mfma_f32_16x16x32_bf16 v[0:3], v[120:123], v[100:103], v[0:3]
    ds_read_b128 v[68:71], v136 offset:40960
    s_lshl_b32 s20, s57, 1
    s_add_u32 m0, s20, 0
    v_mfma_f32_16x16x32_bf16 v[4:7], v[120:123], v[104:107], v[4:7]
    buffer_load_dwordx4 v146, s[24:27], s50 offen nt lds
    ds_read_b128 v[72:75], v136 offset:43008
    v_mfma_f32_16x16x32_bf16 v[8:11], v[120:123], v[108:111], v[8:11]
    ds_read_b128 v[76:79], v136 offset:45056
    v_mfma_f32_16x16x32_bf16 v[12:15], v[120:123], v[112:115], v[12:15]
    ds_read_b128 v[80:83], v136 offset:47104
    v_mfma_f32_16x16x32_bf16 v[48:51], v[132:135], v[116:119], v[48:51]
    ds_read_b128 v[84:87], v140 offset:40960
    v_mfma_f32_16x16x32_bf16 v[16:19], v[124:127], v[100:103], v[16:19]
    ds_read_b64_tr_b16 v[88:89], v144 offset:40960
    s_add_u32 m0, m0, 1024
    v_mfma_f32_16x16x32_bf16 v[20:23], v[124:127], v[104:107], v[20:23]
    buffer_load_dwordx4 v147, s[24:27], s50 offen nt lds
    ds_read_b64_tr_b16 v[90:91], v144 offset:41472
    v_mfma_f32_16x16x32_bf16 v[24:27], v[124:127], v[108:111], v[24:27]
    ds_read_b64_tr_b16 v[92:93], v144 offset:49152
    v_mfma_f32_16x16x32_bf16 v[28:31], v[124:127], v[112:115], v[28:31]
    ds_read_b64_tr_b16 v[94:95], v144 offset:49664
    v_mfma_f32_16x16x32_bf16 v[52:55], v[116:119], v[116:119], v[52:55]
    ds_read_b64_tr_b16 v[96:97], v144 offset:57344
    v_mfma_f32_16x16x32_bf16 v[32:35], v[128:131], v[100:103], v[32:35]
    ds_read_b64_tr_b16 v[98:99], v144 offset:57856
    s_lshl_b32 s51, s23, s54
    s_add_u32 m0, s57, 16384
    v_mfma_f32_16x16x32_bf16 v[36:39], v[128:131], v[104:107], v[36:39]
    buffer_load_dwordx4 v148, s[32:35], s51 offen lds
    v_mfma_f32_16x16x32_bf16 v[40:43], v[128:131], v[108:111], v[40:43]
    v_mfma_f32_16x16x32_bf16 v[44:47], v[128:131], v[112:115], v[44:47]
    v_mfma_f32_16x16x32_bf16 v[56:59], v[120:123], v[132:135], v[56:59]
    v_mfma_f32_16x16x32_bf16 v[64:67], v[128:131], v[132:135], v[64:67]
    s_waitcnt lgkmcnt(0)
    v_mfma_f32_16x16x32_bf16 v[0:3], v[88:91], v[68:71], v[0:3]
    ds_read_b128 v[100:103], v137 offset:40960
    s_lshl_b32 s52, s23, s55
    s_add_u32 m0, s57, 24576
    v_mfma_f32_16x16x32_bf16 v[4:7], v[88:91], v[72:75], v[4:7]
    buffer_load_dwordx4 v149, s[36:39], s52 offen lds
    ds_read_b128 v[104:107], v137 offset:43008
    v_mfma_f32_16x16x32_bf16 v[8:11], v[88:91], v[76:79], v[8:11]
    ds_read_b128 v[108:111], v137 offset:45056
    v_mfma_f32_16x16x32_bf16 v[12:15], v[88:91], v[80:83], v[12:15]
    ds_read_b128 v[112:115], v137 offset:47104
    v_mfma_f32_16x16x32_bf16 v[48:51], v[132:135], v[84:87], v[48:51]
    ds_read_b128 v[116:119], v141 offset:40960
    v_mfma_f32_16x16x32_bf16 v[16:19], v[92:95], v[68:71], v[16:19]
    ds_read_b64_tr_b16 v[120:121], v144 offset:45056
    v_mfma_f32_16x16x32_bf16 v[20:23], v[92:95], v[72:75], v[20:23]
    ds_read_b64_tr_b16 v[122:123], v144 offset:45568
    v_mfma_f32_16x16x32_bf16 v[24:27], v[92:95], v[76:79], v[24:27]
    ds_read_b64_tr_b16 v[124:125], v144 offset:53248
    s_lshl_b32 s53, s23, s56
    s_add_u32 m0, s57, 32768
    v_mfma_f32_16x16x32_bf16 v[28:31], v[92:95], v[80:83], v[28:31]
    buffer_load_dwordx4 v150, s[40:43], s53 offen lds
    s_add_u32 s23, s23, 1
    s_and_b32 s23, s23, 7
    s_lshl_b32 s50, s23, 7
    ds_read_b64_tr_b16 v[126:127], v144 offset:53760
    v_mfma_f32_16x16x32_bf16 v[52:55], v[84:87], v[84:87], v[52:55]
    ds_read_b64_tr_b16 v[128:129], v144 offset:61440
    v_mfma_f32_16x16x32_bf16 v[32:35], v[96:99], v[68:71], v[32:35]
    ds_read_b64_tr_b16 v[130:131], v144 offset:61952
    v_mfma_f32_16x16x32_bf16 v[36:39], v[96:99], v[72:75], v[36:39]
    v_mfma_f32_16x16x32_bf16 v[40:43], v[96:99], v[76:79], v[40:43]
    v_mfma_f32_16x16x32_bf16 v[44:47], v[96:99], v[80:83], v[44:47]
    v_mfma_f32_16x16x32_bf16 v[60:63], v[92:95], v[132:135], v[60:63]
    s_waitcnt vmcnt(5) lgkmcnt(0)
    s_barrier
    v_mfma_f32_16x16x32_bf16 v[0:3], v[120:123], v[100:103], v[0:3]
    ds_read_b128 v[68:71], v138 offset:0
    s_lshl_b32 s20, s57, 1
    s_add_u32 m0, s20, 40960
    v_mfma_f32_16x16x32_bf16 v[4:7], v[120:123], v[104:107], v[4:7]
    buffer_load_dwordx4 v146, s[24:27], s50 offen nt lds
    ds_read_b128 v[72:75], v138 offset:2048
    v_mfma_f32_16x16x32_bf16 v[8:11], v[120:123], v[108:111], v[8:11]
    ds_read_b128 v[76:79], v138 offset:4096
    v_mfma_f32_16x16x32_bf16 v[12:15], v[120:123], v[112:115], v[12:15]
    ds_read_b128 v[80:83], v138 offset:6144
    v_mfma_f32_16x16x32_bf16 v[48:51], v[132:135], v[116:119], v[48:51]
    ds_read_b128 v[84:87], v142 offset:0
    v_mfma_f32_16x16x32_bf16 v[16:19], v[124:127], v[100:103], v[16:19]
    ds_read_b64_tr_b16 v[88:89], v145 offset:0
    s_add_u32 m0, m0, 1024
    v_mfma_f32_16x16x32_bf16 v[20:23], v[124:127], v[104:107], v[20:23]
    buffer_load_dwordx4 v147, s[24:27], s50 offen nt lds
    ds_read_b64_tr_b16 v[90:91], v145 offset:512
    v_mfma_f32_16x16x32_bf16 v[24:27], v[124:127], v[108:111], v[24:27]
    ds_read_b64_tr_b16 v[92:93], v145 offset:8192
    v_mfma_f32_16x16x32_bf16 v[28:31], v[124:127], v[112:115], v[28:31]
    ds_read_b64_tr_b16 v[94:95], v145 offset:8704
    v_mfma_f32_16x16x32_bf16 v[52:55], v[116:119], v[116:119], v[52:55]
    ds_read_b64_tr_b16 v[96:97], v145 offset:16384
    v_mfma_f32_16x16x32_bf16 v[32:35], v[128:131], v[100:103], v[32:35]
    ds_read_b64_tr_b16 v[98:99], v145 offset:16896
    s_lshl_b32 s51, s23, s54
    s_add_u32 m0, s57, 57344
    v_mfma_f32_16x16x32_bf16 v[36:39], v[128:131], v[104:107], v[36:39]
    buffer_load_dwordx4 v148, s[32:35], s51 offen lds
    v_mfma_f32_16x16x32_bf16 v[40:43], v[128:131], v[108:111], v[40:43]
    v_mfma_f32_16x16x32_bf16 v[44:47], v[128:131], v[112:115], v[44:47]
    v_mfma_f32_16x16x32_bf16 v[56:59], v[120:123], v[132:135], v[56:59]
    v_mfma_f32_16x16x32_bf16 v[64:67], v[128:131], v[132:135], v[64:67]
    s_waitcnt lgkmcnt(0)
    v_mfma_f32_16x16x32_bf16 v[0:3], v[88:91], v[68:71], v[0:3]
    ds_read_b128 v[100:103], v139 offset:0
    s_lshl_b32 s52, s23, s55
    s_add_u32 m0, s57, 65536
    v_mfma_f32_16x16x32_bf16 v[4:7], v[88:91], v[72:75], v[4:7]
    buffer_load_dwordx4 v149, s[36:39], s52 offen lds
    ds_read_b128 v[104:107], v139 offset:2048
    v_mfma_f32_16x16x32_bf16 v[8:11], v[88:91], v[76:79], v[8:11]
    ds_read_b128 v[108:111], v139 offset:4096
    v_mfma_f32_16x16x32_bf16 v[12:15], v[88:91], v[80:83], v[12:15]
    ds_read_b128 v[112:115], v139 offset:6144
    v_mfma_f32_16x16x32_bf16 v[48:51], v[132:135], v[84:87], v[48:51]
    ds_read_b128 v[116:119], v143 offset:0
    v_mfma_f32_16x16x32_bf16 v[16:19], v[92:95], v[68:71], v[16:19]
    ds_read_b64_tr_b16 v[120:121], v145 offset:4096
    v_mfma_f32_16x16x32_bf16 v[20:23], v[92:95], v[72:75], v[20:23]
    ds_read_b64_tr_b16 v[122:123], v145 offset:4608
    v_mfma_f32_16x16x32_bf16 v[24:27], v[92:95], v[76:79], v[24:27]
    ds_read_b64_tr_b16 v[124:125], v145 offset:12288
    s_lshl_b32 s53, s23, s56
    s_add_u32 m0, s57, 73728
    v_mfma_f32_16x16x32_bf16 v[28:31], v[92:95], v[80:83], v[28:31]
    buffer_load_dwordx4 v150, s[40:43], s53 offen lds
    s_add_u32 s23, s23, 1
    s_and_b32 s23, s23, 7
    s_lshl_b32 s50, s23, 7
    ds_read_b64_tr_b16 v[126:127], v145 offset:12800
    v_mfma_f32_16x16x32_bf16 v[52:55], v[84:87], v[84:87], v[52:55]
    ds_read_b64_tr_b16 v[128:129], v145 offset:20480
    v_mfma_f32_16x16x32_bf16 v[32:35], v[96:99], v[68:71], v[32:35]
    ds_read_b64_tr_b16 v[130:131], v145 offset:20992
    v_mfma_f32_16x16x32_bf16 v[36:39], v[96:99], v[72:75], v[36:39]
    v_mfma_f32_16x16x32_bf16 v[40:43], v[96:99], v[76:79], v[40:43]
    v_mfma_f32_16x16x32_bf16 v[44:47], v[96:99], v[80:83], v[44:47]
    v_mfma_f32_16x16x32_bf16 v[60:63], v[92:95], v[132:135], v[60:63]
    s_waitcnt vmcnt(5) lgkmcnt(0)
    s_barrier
    v_mfma_f32_16x16x32_bf16 v[0:3], v[120:123], v[100:103], v[0:3]
    ds_read_b128 v[68:71], v136 offset:0
    v_mfma_f32_16x16x32_bf16 v[4:7], v[120:123], v[104:107], v[4:7]
    ds_read_b128 v[72:75], v136 offset:2048
    v_mfma_f32_16x16x32_bf16 v[8:11], v[120:123], v[108:111], v[8:11]
    ds_read_b128 v[76:79], v136 offset:4096
    v_mfma_f32_16x16x32_bf16 v[12:15], v[120:123], v[112:115], v[12:15]
    ds_read_b128 v[80:83], v136 offset:6144
    v_mfma_f32_16x16x32_bf16 v[48:51], v[132:135], v[116:119], v[48:51]
    ds_read_b128 v[84:87], v140 offset:0
    v_mfma_f32_16x16x32_bf16 v[16:19], v[124:127], v[100:103], v[16:19]
    ds_read_b64_tr_b16 v[88:89], v144 offset:0
    v_mfma_f32_16x16x32_bf16 v[20:23], v[124:127], v[104:107], v[20:23]
    ds_read_b64_tr_b16 v[90:91], v144 offset:512
    v_mfma_f32_16x16x32_bf16 v[24:27], v[124:127], v[108:111], v[24:27]
    ds_read_b64_tr_b16 v[92:93], v144 offset:8192
    v_mfma_f32_16x16x32_bf16 v[28:31], v[124:127], v[112:115], v[28:31]
    ds_read_b64_tr_b16 v[94:95], v144 offset:8704
    v_mfma_f32_16x16x32_bf16 v[52:55], v[116:119], v[116:119], v[52:55]
    ds_read_b64_tr_b16 v[96:97], v144 offset:16384
    v_mfma_f32_16x16x32_bf16 v[32:35], v[128:131], v[100:103], v[32:35]
    ds_read_b64_tr_b16 v[98:99], v144 offset:16896
    v_mfma_f32_16x16x32_bf16 v[36:39], v[128:131], v[104:107], v[36:39]
    v_mfma_f32_16x16x32_bf16 v[40:43], v[128:131], v[108:111], v[40:43]
    v_mfma_f32_16x16x32_bf16 v[44:47], v[128:131], v[112:115], v[44:47]
    v_mfma_f32_16x16x32_bf16 v[56:59], v[120:123], v[132:135], v[56:59]
    v_mfma_f32_16x16x32_bf16 v[64:67], v[128:131], v[132:135], v[64:67]
    s_waitcnt lgkmcnt(0)
    v_mfma_f32_16x16x32_bf16 v[0:3], v[88:91], v[68:71], v[0:3]
    ds_read_b128 v[100:103], v137 offset:0
    v_mfma_f32_16x16x32_bf16 v[4:7], v[88:91], v[72:75], v[4:7]
    ds_read_b128 v[104:107], v137 offset:2048
    v_mfma_f32_16x16x32_bf16 v[8:11], v[88:91], v[76:79], v[8:11]
    ds_read_b128 v[108:111], v137 offset:4096
    v_mfma_f32_16x16x32_bf16 v[12:15], v[88:91], v[80:83], v[12:15]
    ds_read_b128 v[112:115], v137 offset:6144
    v_mfma_f32_16x16x32_bf16 v[48:51], v[132:135], v[84:87], v[48:51]
    ds_read_b128 v[116:119], v141 offset:0
    v_mfma_f32_16x16x32_bf16 v[16:19], v[92:95], v[68:71], v[16:19]
    ds_read_b64_tr_b16 v[120:121], v144 offset:4096
    v_mfma_f32_16x16x32_bf16 v[20:23], v[92:95], v[72:75], v[20:23]
    ds_read_b64_tr_b16 v[122:123], v144 offset:4608
    v_mfma_f32_16x16x32_bf16 v[24:27], v[92:95], v[76:79], v[24:27]
    ds_read_b64_tr_b16 v[124:125], v144 offset:12288
    v_mfma_f32_16x16x32_bf16 v[28:31], v[92:95], v[80:83], v[28:31]
    ds_read_b64_tr_b16 v[126:127], v144 offset:12800
    v_mfma_f32_16x16x32_bf16 v[52:55], v[84:87], v[84:87], v[52:55]
    ds_read_b64_tr_b16 v[128:129], v144 offset:20480
    v_mfma_f32_16x16x32_bf16 v[32:35], v[96:99], v[68:71], v[32:35]
    ds_read_b64_tr_b16 v[130:131], v144 offset:20992
    v_mfma_f32_16x16x32_bf16 v[36:39], v[96:99], v[72:75], v[36:39]
    v_mfma_f32_16x16x32_bf16 v[40:43], v[96:99], v[76:79], v[40:43]
    v_mfma_f32_16x16x32_bf16 v[44:47], v[96:99], v[80:83], v[44:47]
    v_mfma_f32_16x16x32_bf16 v[60:63], v[92:95], v[132:135], v[60:63]
    s_waitcnt vmcnt(0) lgkmcnt(0)
    s_barrier
    v_mfma_f32_16x16x32_bf16 v[0:3], v[120:123], v[100:103], v[0:3]
    ds_read_b128 v[68:71], v136 offset:40960
    v_mfma_f32_16x16x32_bf16 v[4:7], v[120:123], v[104:107], v[4:7]
    ds_read_b128 v[72:75], v136 offset:43008
    v_mfma_f32_16x16x32_bf16 v[8:11], v[120:123], v[108:111], v[8:11]
    ds_read_b128 v[76:79], v136 offset:45056
    v_mfma_f32_16x16x32_bf16 v[12:15], v[120:123], v[112:115], v[12:15]
    ds_read_b128 v[80:83], v136 offset:47104
    v_mfma_f32_16x16x32_bf16 v[48:51], v[132:135], v[116:119], v[48:51]
    ds_read_b128 v[84:87], v140 offset:40960
    v_mfma_f32_16x16x32_bf16 v[16:19], v[124:127], v[100:103], v[16:19]
    ds_read_b64_tr_b16 v[88:89], v144 offset:40960
    v_mfma_f32_16x16x32_bf16 v[20:23], v[124:127], v[104:107], v[20:23]
    ds_read_b64_tr_b16 v[90:91], v144 offset:41472
    v_mfma_f32_16x16x32_bf16 v[24:27], v[124:127], v[108:111], v[24:27]
    ds_read_b64_tr_b16 v[92:93], v144 offset:49152
    v_mfma_f32_16x16x32_bf16 v[28:31], v[124:127], v[112:115], v[28:31]
    ds_read_b64_tr_b16 v[94:95], v144 offset:49664
    v_mfma_f32_16x16x32_bf16 v[52:55], v[116:119], v[116:119], v[52:55]
    ds_read_b64_tr_b16 v[96:97], v144 offset:57344
    v_mfma_f32_16x16x32_bf16 v[32:35], v[128:131], v[100:103], v[32:35]
    ds_read_b64_tr_b16 v[98:99], v144 offset:57856
    v_mfma_f32_16x16x32_bf16 v[36:39], v[128:131], v[104:107], v[36:39]
    v_mfma_f32_16x16x32_bf16 v[40:43], v[128:131], v[108:111], v[40:43]
    v_mfma_f32_16x16x32_bf16 v[44:47], v[128:131], v[112:115], v[44:47]
    v_mfma_f32_16x16x32_bf16 v[56:59], v[120:123], v[132:135], v[56:59]
    v_mfma_f32_16x16x32_bf16 v[64:67], v[128:131], v[132:135], v[64:67]
    s_waitcnt lgkmcnt(0)
    v_mfma_f32_16x16x32_bf16 v[0:3], v[88:91], v[68:71], v[0:3]
    ds_read_b128 v[100:103], v137 offset:40960
    v_mfma_f32_16x16x32_bf16 v[4:7], v[88:91], v[72:75], v[4:7]
    ds_read_b128 v[104:107], v137 offset:43008
    v_mfma_f32_16x16x32_bf16 v[8:11], v[88:91], v[76:79], v[8:11]
    ds_read_b128 v[108:111], v137 offset:45056
    v_mfma_f32_16x16x32_bf16 v[12:15], v[88:91], v[80:83], v[12:15]
    ds_read_b128 v[112:115], v137 offset:47104
    v_mfma_f32_16x16x32_bf16 v[48:51], v[132:135], v[84:87], v[48:51]
    ds_read_b128 v[116:119], v141 offset:40960
    v_mfma_f32_16x16x32_bf16 v[16:19], v[92:95], v[68:71], v[16:19]
    ds_read_b64_tr_b16 v[120:121], v144 offset:45056
    v_mfma_f32_16x16x32_bf16 v[20:23], v[92:95], v[72:75], v[20:23]
    ds_read_b64_tr_b16 v[122:123], v144 offset:45568
    v_mfma_f32_16x16x32_bf16 v[24:27], v[92:95], v[76:79], v[24:27]
    ds_read_b64_tr_b16 v[124:125], v144 offset:53248
    v_mfma_f32_16x16x32_bf16 v[28:31], v[92:95], v[80:83], v[28:31]
    ds_read_b64_tr_b16 v[126:127], v144 offset:53760
    v_mfma_f32_16x16x32_bf16 v[52:55], v[84:87], v[84:87], v[52:55]
    ds_read_b64_tr_b16 v[128:129], v144 offset:61440
    v_mfma_f32_16x16x32_bf16 v[32:35], v[96:99], v[68:71], v[32:35]
    ds_read_b64_tr_b16 v[130:131], v144 offset:61952
    v_mfma_f32_16x16x32_bf16 v[36:39], v[96:99], v[72:75], v[36:39]
    v_mfma_f32_16x16x32_bf16 v[40:43], v[96:99], v[76:79], v[40:43]
    v_mfma_f32_16x16x32_bf16 v[44:47], v[96:99], v[80:83], v[44:47]
    v_mfma_f32_16x16x32_bf16 v[60:63], v[92:95], v[132:135], v[60:63]
    s_waitcnt lgkmcnt(0)
    v_mfma_f32_16x16x32_bf16 v[48:51], v[132:135], v[116:119], v[48:51]
    v_mfma_f32_16x16x32_bf16 v[52:55], v[116:119], v[116:119], v[52:55]
    v_mfma_f32_16x16x32_bf16 v[56:59], v[120:123], v[132:135], v[56:59]
    v_mfma_f32_16x16x32_bf16 v[64:67], v[128:131], v[132:135], v[64:67]
    v_mfma_f32_16x16x32_bf16 v[0:3], v[120:123], v[100:103], v[0:3]
    v_mfma_f32_16x16x32_bf16 v[4:7], v[120:123], v[104:107], v[4:7]
    v_mfma_f32_16x16x32_bf16 v[8:11], v[120:123], v[108:111], v[8:11]
    v_cmp_eq_u32 vcc, 1, v166
    s_nop 1
    v_cndmask_b32 v68, v52, v53, vcc
    v_mfma_f32_16x16x32_bf16 v[12:15], v[120:123], v[112:115], v[12:15]
    v_cmp_eq_u32 vcc, 2, v166
    s_nop 1
    v_cndmask_b32 v68, v68, v54, vcc
    v_mfma_f32_16x16x32_bf16 v[16:19], v[124:127], v[100:103], v[16:19]
    v_cmp_eq_u32 vcc, 3, v166
    s_nop 1
    v_cndmask_b32 v68, v68, v55, vcc
    v_mfma_f32_16x16x32_bf16 v[20:23], v[124:127], v[104:107], v[20:23]
    s_mov_b32 s21, 0x3b000000
    v_mul_f32 v70, s21, v48
    v_mul_f32 v68, s21, v68
    v_mfma_f32_16x16x32_bf16 v[24:27], v[124:127], v[108:111], v[24:27]
    v_fma_f32 v71, -v70, v70, v68
    s_mov_b32 s21, 0x3727c5ac
    v_mfma_f32_16x16x32_bf16 v[28:31], v[124:127], v[112:115], v[28:31]
    v_max_f32 v71, 0, v71
    v_add_f32 v71, s21, v71
    v_mfma_f32_16x16x32_bf16 v[32:35], v[128:131], v[100:103], v[32:35]
    v_rsq_f32 v71, v71
    v_sub_f32 v70, 0, v70
    v_mfma_f32_16x16x32_bf16 v[36:39], v[128:131], v[104:107], v[36:39]
    s_mov_b64 exec, s[96:97]
    ds_write_b128 v159, v[56:59] offset:1024
    ds_write_b128 v159, v[60:63] offset:1088
    ds_write_b128 v159, v[64:67] offset:1152
    s_mov_b64 exec, -1
    v_mfma_f32_16x16x32_bf16 v[40:43], v[128:131], v[108:111], v[40:43]
    s_mov_b64 exec, s[94:95]
    ds_write_b64 v158, v[70:71] offset:0
    s_mov_b64 exec, -1
    v_mfma_f32_16x16x32_bf16 v[44:47], v[128:131], v[112:115], v[44:47]
    s_branch K1EPI_8
K1V_7:
    ds_read_b128 v[68:71], v136 offset:0
    ds_read_b128 v[72:75], v136 offset:2048
    ds_read_b128 v[76:79], v136 offset:4096
    ds_read_b128 v[80:83], v136 offset:6144
    ds_read_b64_tr_b16 v[88:89], v144 offset:0
    ds_read_b64_tr_b16 v[90:91], v144 offset:512
    ds_read_b64_tr_b16 v[92:93], v144 offset:8192
    ds_read_b64_tr_b16 v[94:95], v144 offset:8704
    ds_read_b64_tr_b16 v[96:97], v144 offset:16384
    ds_read_b64_tr_b16 v[98:99], v144 offset:16896
    s_waitcnt lgkmcnt(0)
    v_mfma_f32_16x16x32_bf16 v[0:3], v[68:71], v[88:91], 0
    ds_read_b128 v[100:103], v137 offset:0
    s_lshl_b32 s20, s57, 1
    s_add_u32 m0, s20, 81920
    v_mfma_f32_16x16x32_bf16 v[4:7], v[72:75], v[88:91], 0
    buffer_load_dwordx4 v146, s[24:27], s50 offen nt lds
    ds_read_b128 v[104:107], v137 offset:2048
    v_mfma_f32_16x16x32_bf16 v[8:11], v[76:79], v[88:91], 0
    ds_read_b128 v[108:111], v137 offset:4096
    s_add_u32 m0, m0, 1024
    v_mfma_f32_16x16x32_bf16 v[12:15], v[80:83], v[88:91], 0
    buffer_load_dwordx4 v147, s[24:27], s50 offen nt lds
    ds_read_b128 v[112:115], v137 offset:6144
    v_mfma_f32_16x16x32_bf16 v[16:19], v[68:71], v[92:95], 0
    ds_read_b64_tr_b16 v[120:121], v144 offset:4096
    s_lshl_b32 s51, s23, s54
    s_add_u32 m0, s57, 98304
    v_mfma_f32_16x16x32_bf16 v[20:23], v[72:75], v[92:95], 0
    buffer_load_dwordx4 v148, s[32:35], s51 offen lds
    ds_read_b64_tr_b16 v[122:123], v144 offset:4608
    v_mfma_f32_16x16x32_bf16 v[24:27], v[76:79], v[92:95], 0
    ds_read_b64_tr_b16 v[124:125], v144 offset:12288
    s_lshl_b32 s52, s23, s55
    s_add_u32 m0, s57, 106496
    v_mfma_f32_16x16x32_bf16 v[28:31], v[80:83], v[92:95], 0
    buffer_load_dwordx4 v149, s[36:39], s52 offen lds
    ds_read_b64_tr_b16 v[126:127], v144 offset:12800
    v_mfma_f32_16x16x32_bf16 v[32:35], v[68:71], v[96:99], 0
    ds_read_b64_tr_b16 v[128:129], v144 offset:20480
    s_lshl_b32 s53, s23, s56
    s_add_u32 m0, s57, 114688
    v_mfma_f32_16x16x32_bf16 v[36:39], v[72:75], v[96:99], 0
    buffer_load_dwordx4 v150, s[40:43], s53 offen lds
    s_add_u32 s23, s23, 1
    s_and_b32 s23, s23, 7
    s_lshl_b32 s50, s23, 7
    ds_read_b64_tr_b16 v[130:131], v144 offset:20992
    v_mfma_f32_16x16x32_bf16 v[40:43], v[76:79], v[96:99], 0
    v_mfma_f32_16x16x32_bf16 v[44:47], v[80:83], v[96:99], 0
    s_waitcnt vmcnt(5) lgkmcnt(0)
    s_barrier
    v_mfma_f32_16x16x32_bf16 v[0:3], v[100:103], v[120:123], v[0:3]
    ds_read_b128 v[68:71], v136 offset:40960
    s_lshl_b32 s20, s57, 1
    s_add_u32 m0, s20, 0
    v_mfma_f32_16x16x32_bf16 v[4:7], v[104:107], v[120:123], v[4:7]
    buffer_load_dwordx4 v146, s[24:27], s50 offen nt lds
    ds_read_b128 v[72:75], v136 offset:43008
    v_mfma_f32_16x16x32_bf16 v[8:11], v[108:111], v[120:123], v[8:11]
    ds_read_b128 v[76:79], v136 offset:45056
    v_mfma_f32_16x16x32_bf16 v[12:15], v[112:115], v[120:123], v[12:15]
    ds_read_b128 v[80:83], v136 offset:47104
    s_add_u32 m0, m0, 1024
    v_mfma_f32_16x16x32_bf16 v[16:19], v[100:103], v[124:127], v[16:19]
    buffer_load_dwordx4 v147, s[24:27], s50 offen nt lds
    ds_read_b64_tr_b16 v[88:89], v144 offset:40960
    v_mfma_f32_16x16x32_bf16 v[20:23], v[104:107], v[124:127], v[20:23]
    ds_read_b64_tr_b16 v[90:91], v144 offset:41472
    v_mfma_f32_16x16x32_bf16 v[24:27], v[108:111], v[124:127], v[24:27]
    ds_read_b64_tr_b16 v[92:93], v144 offset:49152
    v_mfma_f32_16x16x32_bf16 v[28:31], v[112:115], v[124:127], v[28:31]
    ds_read_b64_tr_b16 v[94:95], v144 offset:49664
    s_lshl_b32 s51, s23, s54
    s_add_u32 m0, s57, 16384
    v_mfma_f32_16x16x32_bf16 v[32:35], v[100:103], v[128:131], v[32:35]
    buffer_load_dwordx4 v148, s[32:35], s51 offen lds
    ds_read_b64_tr_b16 v[96:97], v144 offset:57344
    v_mfma_f32_16x16x32_bf16 v[36:39], v[104:107], v[128:131], v[36:39]
    ds_read_b64_tr_b16 v[98:99], v144 offset:57856
    v_mfma_f32_16x16x32_bf16 v[40:43], v[108:111], v[128:131], v[40:43]
    v_mfma_f32_16x16x32_bf16 v[44:47], v[112:115], v[128:131], v[44:47]
    s_waitcnt lgkmcnt(0)
    v_mfma_f32_16x16x32_bf16 v[0:3], v[68:71], v[88:91], v[0:3]
    ds_read_b128 v[100:103], v137 offset:40960
    s_lshl_b32 s52, s23, s55
    s_add_u32 m0, s57, 24576
    v_mfma_f32_16x16x32_bf16 v[4:7], v[72:75], v[88:91], v[4:7]
    buffer_load_dwordx4 v149, s[36:39], s52 offen lds
    ds_read_b128 v[104:107], v137 offset:43008
    v_mfma_f32_16x16x32_bf16 v[8:11], v[76:79], v[88:91], v[8:11]
    ds_read_b128 v[108:111], v137 offset:45056
    v_mfma_f32_16x16x32_bf16 v[12:15], v[80:83], v[88:91], v[12:15]
    ds_read_b128 v[112:115], v137 offset:47104
    v_mfma_f32_16x16x32_bf16 v[16:19], v[68:71], v[92:95], v[16:19]
    ds_read_b64_tr_b16 v[120:121], v144 offset:45056
    v_mfma_f32_16x16x32_bf16 v[20:23], v[72:75], v[92:95], v[20:23]
    ds_read_b64_tr_b16 v[122:123], v144 offset:45568
    s_lshl_b32 s53, s23, s56
    s_add_u32 m0, s57, 32768
    v_mfma_f32_16x16x32_bf16 v[24:27], v[76:79], v[92:95], v[24:27]
    buffer_load_dwordx4 v150, s[40:43], s53 offen lds
    s_add_u32 s23, s23, 1
    s_and_b32 s23, s23, 7
    s_lshl_b32 s50, s23, 7
    ds_read_b64_tr_b16 v[124:125], v144 offset:53248
    v_mfma_f32_16x16x32_bf16 v[28:31], v[80:83], v[92:95], v[28:31]
    ds_read_b64_tr_b16 v[126:127], v144 offset:53760
    v_mfma_f32_16x16x32_bf16 v[32:35], v[68:71], v[96:99], v[32:35]
    ds_read_b64_tr_b16 v[128:129], v144 offset:61440
    v_mfma_f32_16x16x32_bf16 v[36:39], v[72:75], v[96:99], v[36:39]
    ds_read_b64_tr_b16 v[130:131], v144 offset:61952
    v_mfma_f32_16x16x32_bf16 v[40:43], v[76:79], v[96:99], v[40:43]
    v_mfma_f32_16x16x32_bf16 v[44:47], v[80:83], v[96:99], v[44:47]
    s_waitcnt vmcnt(5) lgkmcnt(0)
    s_barrier
    v_mfma_f32_16x16x32_bf16 v[0:3], v[100:103], v[120:123], v[0:3]
    ds_read_b128 v[68:71], v138 offset:0
    s_lshl_b32 s20, s57, 1
    s_add_u32 m0, s20, 40960
    v_mfma_f32_16x16x32_bf16 v[4:7], v[104:107], v[120:123], v[4:7]
    buffer_load_dwordx4 v146, s[24:27], s50 offen nt lds
    ds_read_b128 v[72:75], v138 offset:2048
    v_mfma_f32_16x16x32_bf16 v[8:11], v[108:111], v[120:123], v[8:11]
    ds_read_b128 v[76:79], v138 offset:4096
    v_mfma_f32_16x16x32_bf16 v[12:15], v[112:115], v[120:123], v[12:15]
    ds_read_b128 v[80:83], v138 offset:6144
    s_add_u32 m0, m0, 1024
    v_mfma_f32_16x16x32_bf16 v[16:19], v[100:103], v[124:127], v[16:19]
    buffer_load_dwordx4 v147, s[24:27], s50 offen nt lds
    ds_read_b64_tr_b16 v[88:89], v145 offset:0
    v_mfma_f32_16x16x32_bf16 v[20:23], v[104:107], v[124:127], v[20:23]
    ds_read_b64_tr_b16 v[90:91], v145 offset:512
    v_mfma_f32_16x16x32_bf16 v[24:27], v[108:111], v[124:127], v[24:27]
    ds_read_b64_tr_b16 v[92:93], v145 offset:8192
    v_mfma_f32_16x16x32_bf16 v[28:31], v[112:115], v[124:127], v[28:31]
    ds_read_b64_tr_b16 v[94:95], v145 offset:8704
    s_lshl_b32 s51, s23, s54
    s_add_u32 m0, s57, 57344
    v_mfma_f32_16x16x32_bf16 v[32:35], v[100:103], v[128:131], v[32:35]
    buffer_load_dwordx4 v148, s[32:35], s51 offen lds
    ds_read_b64_tr_b16 v[96:97], v145 offset:16384
    v_mfma_f32_16x16x32_bf16 v[36:39], v[104:107], v[128:131], v[36:39]
    ds_read_b64_tr_b16 v[98:99], v145 offset:16896
    v_mfma_f32_16x16x32_bf16 v[40:43], v[108:111], v[128:131], v[40:43]
    v_mfma_f32_16x16x32_bf16 v[44:47], v[112:115], v[128:131], v[44:47]
    s_waitcnt lgkmcnt(0)
    v_mfma_f32_16x16x32_bf16 v[0:3], v[68:71], v[88:91], v[0:3]
    ds_read_b128 v[100:103], v139 offset:0
    s_lshl_b32 s52, s23, s55
    s_add_u32 m0, s57, 65536
    v_mfma_f32_16x16x32_bf16 v[4:7], v[72:75], v[88:91], v[4:7]
    buffer_load_dwordx4 v149, s[36:39], s52 offen lds
    ds_read_b128 v[104:107], v139 offset:2048
    v_mfma_f32_16x16x32_bf16 v[8:11], v[76:79], v[88:91], v[8:11]
    ds_read_b128 v[108:111], v139 offset:4096
    v_mfma_f32_16x16x32_bf16 v[12:15], v[80:83], v[88:91], v[12:15]
    ds_read_b128 v[112:115], v139 offset:6144
    v_mfma_f32_16x16x32_bf16 v[16:19], v[68:71], v[92:95], v[16:19]
    ds_read_b64_tr_b16 v[120:121], v145 offset:4096
    v_mfma_f32_16x16x32_bf16 v[20:23], v[72:75], v[92:95], v[20:23]
    ds_read_b64_tr_b16 v[122:123], v145 offset:4608
    s_lshl_b32 s53, s23, s56
    s_add_u32 m0, s57, 73728
    v_mfma_f32_16x16x32_bf16 v[24:27], v[76:79], v[92:95], v[24:27]
    buffer_load_dwordx4 v150, s[40:43], s53 offen lds
    s_add_u32 s23, s23, 1
    s_and_b32 s23, s23, 7
    s_lshl_b32 s50, s23, 7
    ds_read_b64_tr_b16 v[124:125], v145 offset:12288
    v_mfma_f32_16x16x32_bf16 v[28:31], v[80:83], v[92:95], v[28:31]
    ds_read_b64_tr_b16 v[126:127], v145 offset:12800
    v_mfma_f32_16x16x32_bf16 v[32:35], v[68:71], v[96:99], v[32:35]
    ds_read_b64_tr_b16 v[128:129], v145 offset:20480
    v_mfma_f32_16x16x32_bf16 v[36:39], v[72:75], v[96:99], v[36:39]
    ds_read_b64_tr_b16 v[130:131], v145 offset:20992
    v_mfma_f32_16x16x32_bf16 v[40:43], v[76:79], v[96:99], v[40:43]
    v_mfma_f32_16x16x32_bf16 v[44:47], v[80:83], v[96:99], v[44:47]
    s_waitcnt vmcnt(5) lgkmcnt(0)
    s_barrier
    v_mfma_f32_16x16x32_bf16 v[0:3], v[100:103], v[120:123], v[0:3]
    ds_read_b128 v[68:71], v136 offset:0
    s_lshl_b32 s20, s57, 1
    s_add_u32 m0, s20, 81920
    v_mfma_f32_16x16x32_bf16 v[4:7], v[104:107], v[120:123], v[4:7]
    buffer_load_dwordx4 v146, s[24:27], s50 offen nt lds
    ds_read_b128 v[72:75], v136 offset:2048
    v_mfma_f32_16x16x32_bf16 v[8:11], v[108:111], v[120:123], v[8:11]
    ds_read_b128 v[76:79], v136 offset:4096
    v_mfma_f32_16x16x32_bf16 v[12:15], v[112:115], v[120:123], v[12:15]
    ds_read_b128 v[80:83], v136 offset:6144
    s_add_u32 m0, m0, 1024
    v_mfma_f32_16x16x32_bf16 v[16:19], v[100:103], v[124:127], v[16:19]
    buffer_load_dwordx4 v147, s[24:27], s50 offen nt lds
    ds_read_b64_tr_b16 v[88:89], v144 offset:0
    v_mfma_f32_16x16x32_bf16 v[20:23], v[104:107], v[124:127], v[20:23]
    ds_read_b64_tr_b16 v[90:91], v144 offset:512
    v_mfma_f32_16x16x32_bf16 v[24:27], v[108:111], v[124:127], v[24:27]
    ds_read_b64_tr_b16 v[92:93], v144 offset:8192
    v_mfma_f32_16x16x32_bf16 v[28:31], v[112:115], v[124:127], v[28:31]
    ds_read_b64_tr_b16 v[94:95], v144 offset:8704
    s_lshl_b32 s51, s23, s54
    s_add_u32 m0, s57, 98304
    v_mfma_f32_16x16x32_bf16 v[32:35], v[100:103], v[128:131], v[32:35]
    buffer_load_dwordx4 v148, s[32:35], s51 offen lds
    ds_read_b64_tr_b16 v[96:97], v144 offset:16384
    v_mfma_f32_16x16x32_bf16 v[36:39], v[104:107], v[128:131], v[36:39]
    ds_read_b64_tr_b16 v[98:99], v144 offset:16896
    v_mfma_f32_16x16x32_bf16 v[40:43], v[108:111], v[128:131], v[40:43]
    v_mfma_f32_16x16x32_bf16 v[44:47], v[112:115], v[128:131], v[44:47]
    s_waitcnt lgkmcnt(0)
    v_mfma_f32_16x16x32_bf16 v[0:3], v[68:71], v[88:91], v[0:3]
    ds_read_b128 v[100:103], v137 offset:0
    s_lshl_b32 s52, s23, s55
    s_add_u32 m0, s57, 106496
    v_mfma_f32_16x16x32_bf16 v[4:7], v[72:75], v[88:91], v[4:7]
    buffer_load_dwordx4 v149, s[36:39], s52 offen lds
    ds_read_b128 v[104:107], v137 offset:2048
    v_mfma_f32_16x16x32_bf16 v[8:11], v[76:79], v[88:91], v[8:11]
    ds_read_b128 v[108:111], v137 offset:4096
    v_mfma_f32_16x16x32_bf16 v[12:15], v[80:83], v[88:91], v[12:15]
    ds_read_b128 v[112:115], v137 offset:6144
    v_mfma_f32_16x16x32_bf16 v[16:19], v[68:71], v[92:95], v[16:19]
    ds_read_b64_tr_b16 v[120:121], v144 offset:4096
    v_mfma_f32_16x16x32_bf16 v[20:23], v[72:75], v[92:95], v[20:23]
    ds_read_b64_tr_b16 v[122:123], v144 offset:4608
    s_lshl_b32 s53, s23, s56
    s_add_u32 m0, s57, 114688
    v_mfma_f32_16x16x32_bf16 v[24:27], v[76:79], v[92:95], v[24:27]
    buffer_load_dwordx4 v150, s[40:43], s53 offen lds
    s_add_u32 s23, s23, 1
    s_and_b32 s23, s23, 7
    s_lshl_b32 s50, s23, 7
    ds_read_b64_tr_b16 v[124:125], v144 offset:12288
    v_mfma_f32_16x16x32_bf16 v[28:31], v[80:83], v[92:95], v[28:31]
    ds_read_b64_tr_b16 v[126:127], v144 offset:12800
    v_mfma_f32_16x16x32_bf16 v[32:35], v[68:71], v[96:99], v[32:35]
    ds_read_b64_tr_b16 v[128:129], v144 offset:20480
    v_mfma_f32_16x16x32_bf16 v[36:39], v[72:75], v[96:99], v[36:39]
    ds_read_b64_tr_b16 v[130:131], v144 offset:20992
    v_mfma_f32_16x16x32_bf16 v[40:43], v[76:79], v[96:99], v[40:43]
    v_mfma_f32_16x16x32_bf16 v[44:47], v[80:83], v[96:99], v[44:47]
    s_waitcnt vmcnt(5) lgkmcnt(0)
    s_barrier
    v_mfma_f32_16x16x32_bf16 v[0:3], v[100:103], v[120:123], v[0:3]
    ds_read_b128 v[68:71], v136 offset:40960
    s_lshl_b32 s20, s57, 1
    s_add_u32 m0, s20, 0
    v_mfma_f32_16x16x32_bf16 v[4:7], v[104:107], v[120:123], v[4:7]
    buffer_load_dwordx4 v146, s[24:27], s50 offen nt lds
    ds_read_b128 v[72:75], v136 offset:43008
    v_mfma_f32_16x16x32_bf16 v[8:11], v[108:111], v[120:123], v[8:11]
    ds_read_b128 v[76:79], v136 offset:45056
    v_mfma_f32_16x16x32_bf16 v[12:15], v[112:115], v[120:123], v[12:15]
    ds_read_b128 v[80:83], v136 offset:47104
    s_add_u32 m0, m0, 1024
    v_mfma_f32_16x16x32_bf16 v[16:19], v[100:103], v[124:127], v[16:19]
    buffer_load_dwordx4 v147, s[24:27], s50 offen nt lds
    ds_read_b64_tr_b16 v[88:89], v144 offset:40960
    v_mfma_f32_16x16x32_bf16 v[20:23], v[104:107], v[124:127], v[20:23]
    ds_read_b64_tr_b16 v[90:91], v144 offset:41472
    v_mfma_f32_16x16x32_bf16 v[24:27], v[108:111], v[124:127], v[24:27]
    ds_read_b64_tr_b16 v[92:93], v144 offset:49152
    v_mfma_f32_16x16x32_bf16 v[28:31], v[112:115], v[124:127], v[28:31]
    ds_read_b64_tr_b16 v[94:95], v144 offset:49664
    s_lshl_b32 s51, s23, s54
    s_add_u32 m0, s57, 16384
    v_mfma_f32_16x16x32_bf16 v[32:35], v[100:103], v[128:131], v[32:35]
    buffer_load_dwordx4 v148, s[32:35], s51 offen lds
    ds_read_b64_tr_b16 v[96:97], v144 offset:57344
    v_mfma_f32_16x16x32_bf16 v[36:39], v[104:107], v[128:131], v[36:39]
    ds_read_b64_tr_b16 v[98:99], v144 offset:57856
    v_mfma_f32_16x16x32_bf16 v[40:43], v[108:111], v[128:131], v[40:43]
    v_mfma_f32_16x16x32_bf16 v[44:47], v[112:115], v[128:131], v[44:47]
    s_waitcnt lgkmcnt(0)
    v_mfma_f32_16x16x32_bf16 v[0:3], v[68:71], v[88:91], v[0:3]
    ds_read_b128 v[100:103], v137 offset:40960
    s_lshl_b32 s52, s23, s55
    s_add_u32 m0, s57, 24576
    v_mfma_f32_16x16x32_bf16 v[4:7], v[72:75], v[88:91], v[4:7]
    buffer_load_dwordx4 v149, s[36:39], s52 offen lds
    ds_read_b128 v[104:107], v137 offset:43008
    v_mfma_f32_16x16x32_bf16 v[8:11], v[76:79], v[88:91], v[8:11]
    ds_read_b128 v[108:111], v137 offset:45056
    v_mfma_f32_16x16x32_bf16 v[12:15], v[80:83], v[88:91], v[12:15]
    ds_read_b128 v[112:115], v137 offset:47104
    v_mfma_f32_16x16x32_bf16 v[16:19], v[68:71], v[92:95], v[16:19]
    ds_read_b64_tr_b16 v[120:121], v144 offset:45056
    v_mfma_f32_16x16x32_bf16 v[20:23], v[72:75], v[92:95], v[20:23]
    ds_read_b64_tr_b16 v[122:123], v144 offset:45568
    s_lshl_b32 s53, s23, s56
    s_add_u32 m0, s57, 32768
    v_mfma_f32_16x16x32_bf16 v[24:27], v[76:79], v[92:95], v[24:27]
    buffer_load_dwordx4 v150, s[40:43], s53 offen lds
    s_add_u32 s23, s23, 1
    s_and_b32 s23, s23, 7
    s_lshl_b32 s50, s23, 7
    ds_read_b64_tr_b16 v[124:125], v144 offset:53248
    v_mfma_f32_16x16x32_bf16 v[28:31], v[80:83], v[92:95], v[28:31]
    ds_read_b64_tr_b16 v[126:127], v144 offset:53760
    v_mfma_f32_16x16x32_bf16 v[32:35], v[68:71], v[96:99], v[32:35]
    ds_read_b64_tr_b16 v[128:129], v144 offset:61440
    v_mfma_f32_16x16x32_bf16 v[36:39], v[72:75], v[96:99], v[36:39]
    ds_read_b64_tr_b16 v[130:131], v144 offset:61952
    v_mfma_f32_16x16x32_bf16 v[40:43], v[76:79], v[96:99], v[40:43]
    v_mfma_f32_16x16x32_bf16 v[44:47], v[80:83], v[96:99], v[44:47]
    s_waitcnt vmcnt(5) lgkmcnt(0)
    s_barrier
    v_mfma_f32_16x16x32_bf16 v[0:3], v[100:103], v[120:123], v[0:3]
    ds_read_b128 v[68:71], v138 offset:0
    s_lshl_b32 s20, s57, 1
    s_add_u32 m0, s20, 40960
    v_mfma_f32_16x16x32_bf16 v[4:7], v[104:107], v[120:123], v[4:7]
    buffer_load_dwordx4 v146, s[24:27], s50 offen nt lds
    ds_read_b128 v[72:75], v138 offset:2048
    v_mfma_f32_16x16x32_bf16 v[8:11], v[108:111], v[120:123], v[8:11]
    ds_read_b128 v[76:79], v138 offset:4096
    v_mfma_f32_16x16x32_bf16 v[12:15], v[112:115], v[120:123], v[12:15]
    ds_read_b128 v[80:83], v138 offset:6144
    s_add_u32 m0, m0, 1024
    v_mfma_f32_16x16x32_bf16 v[16:19], v[100:103], v[124:127], v[16:19]
    buffer_load_dwordx4 v147, s[24:27], s50 offen nt lds
    ds_read_b64_tr_b16 v[88:89], v145 offset:0
    v_mfma_f32_16x16x32_bf16 v[20:23], v[104:107], v[124:127], v[20:23]
    ds_read_b64_tr_b16 v[90:91], v145 offset:512
    v_mfma_f32_16x16x32_bf16 v[24:27], v[108:111], v[124:127], v[24:27]
    ds_read_b64_tr_b16 v[92:93], v145 offset:8192
    v_mfma_f32_16x16x32_bf16 v[28:31], v[112:115], v[124:127], v[28:31]
    ds_read_b64_tr_b16 v[94:95], v145 offset:8704
    s_lshl_b32 s51, s23, s54
    s_add_u32 m0, s57, 57344
    v_mfma_f32_16x16x32_bf16 v[32:35], v[100:103], v[128:131], v[32:35]
    buffer_load_dwordx4 v148, s[32:35], s51 offen lds
    ds_read_b64_tr_b16 v[96:97], v145 offset:16384
    v_mfma_f32_16x16x32_bf16 v[36:39], v[104:107], v[128:131], v[36:39]
    ds_read_b64_tr_b16 v[98:99], v145 offset:16896
    v_mfma_f32_16x16x32_bf16 v[40:43], v[108:111], v[128:131], v[40:43]
    v_mfma_f32_16x16x32_bf16 v[44:47], v[112:115], v[128:131], v[44:47]
    s_waitcnt lgkmcnt(0)
    v_mfma_f32_16x16x32_bf16 v[0:3], v[68:71], v[88:91], v[0:3]
    ds_read_b128 v[100:103], v139 offset:0
    s_lshl_b32 s52, s23, s55
    s_add_u32 m0, s57, 65536
    v_mfma_f32_16x16x32_bf16 v[4:7], v[72:75], v[88:91], v[4:7]
    buffer_load_dwordx4 v149, s[36:39], s52 offen lds
    ds_read_b128 v[104:107], v139 offset:2048
    v_mfma_f32_16x16x32_bf16 v[8:11], v[76:79], v[88:91], v[8:11]
    ds_read_b128 v[108:111], v139 offset:4096
    v_mfma_f32_16x16x32_bf16 v[12:15], v[80:83], v[88:91], v[12:15]
    ds_read_b128 v[112:115], v139 offset:6144
    v_mfma_f32_16x16x32_bf16 v[16:19], v[68:71], v[92:95], v[16:19]
    ds_read_b64_tr_b16 v[120:121], v145 offset:4096
    v_mfma_f32_16x16x32_bf16 v[20:23], v[72:75], v[92:95], v[20:23]
    ds_read_b64_tr_b16 v[122:123], v145 offset:4608
    s_lshl_b32 s53, s23, s56
    s_add_u32 m0, s57, 73728
    v_mfma_f32_16x16x32_bf16 v[24:27], v[76:79], v[92:95], v[24:27]
    buffer_load_dwordx4 v150, s[40:43], s53 offen lds
    s_add_u32 s23, s23, 1
    s_and_b32 s23, s23, 7
    s_lshl_b32 s50, s23, 7
    ds_read_b64_tr_b16 v[124:125], v145 offset:12288
    v_mfma_f32_16x16x32_bf16 v[28:31], v[80:83], v[92:95], v[28:31]
    ds_read_b64_tr_b16 v[126:127], v145 offset:12800
    v_mfma_f32_16x16x32_bf16 v[32:35], v[68:71], v[96:99], v[32:35]
    ds_read_b64_tr_b16 v[128:129], v145 offset:20480
    v_mfma_f32_16x16x32_bf16 v[36:39], v[72:75], v[96:99], v[36:39]
    ds_read_b64_tr_b16 v[130:131], v145 offset:20992
    v_mfma_f32_16x16x32_bf16 v[40:43], v[76:79], v[96:99], v[40:43]
    v_mfma_f32_16x16x32_bf16 v[44:47], v[80:83], v[96:99], v[44:47]
    s_waitcnt vmcnt(5) lgkmcnt(0)
    s_barrier
    v_mfma_f32_16x16x32_bf16 v[0:3], v[100:103], v[120:123], v[0:3]
    ds_read_b128 v[68:71], v136 offset:0
    v_mfma_f32_16x16x32_bf16 v[4:7], v[104:107], v[120:123], v[4:7]
    ds_read_b128 v[72:75], v136 offset:2048
    v_mfma_f32_16x16x32_bf16 v[8:11], v[108:111], v[120:123], v[8:11]
    ds_read_b128 v[76:79], v136 offset:4096
    v_mfma_f32_16x16x32_bf16 v[12:15], v[112:115], v[120:123], v[12:15]
    ds_read_b128 v[80:83], v136 offset:6144
    v_mfma_f32_16x16x32_bf16 v[16:19], v[100:103], v[124:127], v[16:19]
    ds_read_b64_tr_b16 v[88:89], v144 offset:0
    v_mfma_f32_16x16x32_bf16 v[20:23], v[104:107], v[124:127], v[20:23]
    ds_read_b64_tr_b16 v[90:91], v144 offset:512
    v_mfma_f32_16x16x32_bf16 v[24:27], v[108:111], v[124:127], v[24:27]
    ds_read_b64_tr_b16 v[92:93], v144 offset:8192
    v_mfma_f32_16x16x32_bf16 v[28:31], v[112:115], v[124:127], v[28:31]
    ds_read_b64_tr_b16 v[94:95], v144 offset:8704
    v_mfma_f32_16x16x32_bf16 v[32:35], v[100:103], v[128:131], v[32:35]
    ds_read_b64_tr_b16 v[96:97], v144 offset:16384
    v_mfma_f32_16x16x32_bf16 v[36:39], v[104:107], v[128:131], v[36:39]
    ds_read_b64_tr_b16 v[98:99], v144 offset:16896
    v_mfma_f32_16x16x32_bf16 v[40:43], v[108:111], v[128:131], v[40:43]
    v_mfma_f32_16x16x32_bf16 v[44:47], v[112:115], v[128:131], v[44:47]
    s_waitcnt lgkmcnt(0)
    v_mfma_f32_16x16x32_bf16 v[0:3], v[68:71], v[88:91], v[0:3]
    ds_read_b128 v[100:103], v137 offset:0
    v_mfma_f32_16x16x32_bf16 v[4:7], v[72:75], v[88:91], v[4:7]
    ds_read_b128 v[104:107], v137 offset:2048
    v_mfma_f32_16x16x32_bf16 v[8:11], v[76:79], v[88:91], v[8:11]
    ds_read_b128 v[108:111], v137 offset:4096
    v_mfma_f32_16x16x32_bf16 v[12:15], v[80:83], v[88:91], v[12:15]
    ds_read_b128 v[112:115], v137 offset:6144
    v_mfma_f32_16x16x32_bf16 v[16:19], v[68:71], v[92:95], v[16:19]
    ds_read_b64_tr_b16 v[120:121], v144 offset:4096
    v_mfma_f32_16x16x32_bf16 v[20:23], v[72:75], v[92:95], v[20:23]
    ds_read_b64_tr_b16 v[122:123], v144 offset:4608
    v_mfma_f32_16x16x32_bf16 v[24:27], v[76:79], v[92:95], v[24:27]
    ds_read_b64_tr_b16 v[124:125], v144 offset:12288
    v_mfma_f32_16x16x32_bf16 v[28:31], v[80:83], v[92:95], v[28:31]
    ds_read_b64_tr_b16 v[126:127], v144 offset:12800
    v_mfma_f32_16x16x32_bf16 v[32:35], v[68:71], v[96:99], v[32:35]
    ds_read_b64_tr_b16 v[128:129], v144 offset:20480
    v_mfma_f32_16x16x32_bf16 v[36:39], v[72:75], v[96:99], v[36:39]
    ds_read_b64_tr_b16 v[130:131], v144 offset:20992
    v_mfma_f32_16x16x32_bf16 v[40:43], v[76:79], v[96:99], v[40:43]
    v_mfma_f32_16x16x32_bf16 v[44:47], v[80:83], v[96:99], v[44:47]
    s_waitcnt vmcnt(0) lgkmcnt(0)
    s_barrier
    v_mfma_f32_16x16x32_bf16 v[0:3], v[100:103], v[120:123], v[0:3]
    ds_read_b128 v[68:71], v136 offset:40960
    v_mfma_f32_16x16x32_bf16 v[4:7], v[104:107], v[120:123], v[4:7]
    ds_read_b128 v[72:75], v136 offset:43008
    v_mfma_f32_16x16x32_bf16 v[8:11], v[108:111], v[120:123], v[8:11]
    ds_read_b128 v[76:79], v136 offset:45056
    v_mfma_f32_16x16x32_bf16 v[12:15], v[112:115], v[120:123], v[12:15]
    ds_read_b128 v[80:83], v136 offset:47104
    v_mfma_f32_16x16x32_bf16 v[16:19], v[100:103], v[124:127], v[16:19]
    ds_read_b64_tr_b16 v[88:89], v144 offset:40960
    v_mfma_f32_16x16x32_bf16 v[20:23], v[104:107], v[124:127], v[20:23]
    ds_read_b64_tr_b16 v[90:91], v144 offset:41472
    v_mfma_f32_16x16x32_bf16 v[24:27], v[108:111], v[124:127], v[24:27]
    ds_read_b64_tr_b16 v[92:93], v144 offset:49152
    v_mfma_f32_16x16x32_bf16 v[28:31], v[112:115], v[124:127], v[28:31]
    ds_read_b64_tr_b16 v[94:95], v144 offset:49664
    v_mfma_f32_16x16x32_bf16 v[32:35], v[100:103], v[128:131], v[32:35]
    ds_read_b64_tr_b16 v[96:97], v144 offset:57344
    v_mfma_f32_16x16x32_bf16 v[36:39], v[104:107], v[128:131], v[36:39]
    ds_read_b64_tr_b16 v[98:99], v144 offset:57856
    v_mfma_f32_16x16x32_bf16 v[40:43], v[108:111], v[128:131], v[40:43]
    v_mfma_f32_16x16x32_bf16 v[44:47], v[112:115], v[128:131], v[44:47]
    s_waitcnt lgkmcnt(0)
    v_mfma_f32_16x16x32_bf16 v[0:3], v[68:71], v[88:91], v[0:3]
    ds_read_b128 v[100:103], v137 offset:40960
    v_mfma_f32_16x16x32_bf16 v[4:7], v[72:75], v[88:91], v[4:7]
    ds_read_b128 v[104:107], v137 offset:43008
    v_mfma_f32_16x16x32_bf16 v[8:11], v[76:79], v[88:91], v[8:11]
    ds_read_b128 v[108:111], v137 offset:45056
    v_mfma_f32_16x16x32_bf16 v[12:15], v[80:83], v[88:91], v[12:15]
    ds_read_b128 v[112:115], v137 offset:47104
    v_mfma_f32_16x16x32_bf16 v[16:19], v[68:71], v[92:95], v[16:19]
    ds_read_b64_tr_b16 v[120:121], v144 offset:45056
    v_mfma_f32_16x16x32_bf16 v[20:23], v[72:75], v[92:95], v[20:23]
    ds_read_b64_tr_b16 v[122:123], v144 offset:45568
    v_mfma_f32_16x16x32_bf16 v[24:27], v[76:79], v[92:95], v[24:27]
    ds_read_b64_tr_b16 v[124:125], v144 offset:53248
    v_mfma_f32_16x16x32_bf16 v[28:31], v[80:83], v[92:95], v[28:31]
    ds_read_b64_tr_b16 v[126:127], v144 offset:53760
    v_mfma_f32_16x16x32_bf16 v[32:35], v[68:71], v[96:99], v[32:35]
    ds_read_b64_tr_b16 v[128:129], v144 offset:61440
    v_mfma_f32_16x16x32_bf16 v[36:39], v[72:75], v[96:99], v[36:39]
    ds_read_b64_tr_b16 v[130:131], v144 offset:61952
    v_mfma_f32_16x16x32_bf16 v[40:43], v[76:79], v[96:99], v[40:43]
    v_mfma_f32_16x16x32_bf16 v[44:47], v[80:83], v[96:99], v[44:47]
    s_waitcnt lgkmcnt(0)
    v_mfma_f32_16x16x32_bf16 v[0:3], v[100:103], v[120:123], v[0:3]
    v_mfma_f32_16x16x32_bf16 v[4:7], v[104:107], v[120:123], v[4:7]
    v_mfma_f32_16x16x32_bf16 v[8:11], v[108:111], v[120:123], v[8:11]
    v_mfma_f32_16x16x32_bf16 v[12:15], v[112:115], v[120:123], v[12:15]
    v_mfma_f32_16x16x32_bf16 v[16:19], v[100:103], v[124:127], v[16:19]
    v_mfma_f32_16x16x32_bf16 v[20:23], v[104:107], v[124:127], v[20:23]
    v_mfma_f32_16x16x32_bf16 v[24:27], v[108:111], v[124:127], v[24:27]
    v_mfma_f32_16x16x32_bf16 v[28:31], v[112:115], v[124:127], v[28:31]
    v_mfma_f32_16x16x32_bf16 v[32:35], v[100:103], v[128:131], v[32:35]
    v_mfma_f32_16x16x32_bf16 v[36:39], v[104:107], v[128:131], v[36:39]
    v_mfma_f32_16x16x32_bf16 v[40:43], v[108:111], v[128:131], v[40:43]
    v_mfma_f32_16x16x32_bf16 v[44:47], v[112:115], v[128:131], v[44:47]
    v_and_b32 v152, 15, v151
    v_lshrrev_b32 v153, 4, v151
    s_and_b32 s20, s46, 1
    s_lshl_b32 s20, s20, 4
    v_add_u32 v154, s20, v152
    v_lshrrev_b32 v155, 1, v153
    v_lshl_add_u32 v154, v155, 5, v154
    v_lshlrev_b32 v154, 4, v154
    v_and_b32 v156, 1, v153
    v_lshl_add_u32 v154, v156, 3, v154
    s_cmp_eq_u32 s49, 2
    s_mov_b32 s22, 13041664
    s_cselect_b32 s22, 13582336, s22
    s_lshl_b32 s20, s47, 3
    s_lshl_b32 s21, s45, 2
    s_add_u32 s20, s20, s21
    s_lshl_b32 s20, s20, 10
    s_add_u32 s22, s22, s20
    s_cmp_eq_u32 s58, 3
    s_cbranch_scc1 K1FS_10
    s_lshl_b32 s20, s61, 1
    s_lshr_b32 s21, s46, 1
    s_add_u32 s20, s20, s21
    s_mul_i32 s20, s20, 33792
    s_add_u32 s20, s20, s22
    v_cvt_pk_bf16_f32 v68, v0, v1
    v_cvt_pk_bf16_f32 v69, v2, v3
    buffer_store_dwordx2 v[68:69], v154, s[28:31], s20 offen offset:0 sc1
    v_cvt_pk_bf16_f32 v70, v4, v5
    v_cvt_pk_bf16_f32 v71, v6, v7
    buffer_store_dwordx2 v[70:71], v154, s[28:31], s20 offen offset:1024 sc1
    v_cvt_pk_bf16_f32 v72, v8, v9
    v_cvt_pk_bf16_f32 v73, v10, v11
    buffer_store_dwordx2 v[72:73], v154, s[28:31], s20 offen offset:2048 sc1
    v_cvt_pk_bf16_f32 v74, v12, v13
    v_cvt_pk_bf16_f32 v75, v14, v15
    buffer_store_dwordx2 v[74:75], v154, s[28:31], s20 offen offset:3072 sc1
K1FS_10:
    s_cmp_eq_u32 s59, 3
    s_cbranch_scc1 K1FS_11
    s_lshl_b32 s20, s62, 1
    s_lshr_b32 s21, s46, 1
    s_add_u32 s20, s20, s21
    s_mul_i32 s20, s20, 33792
    s_add_u32 s20, s20, s22
    v_cvt_pk_bf16_f32 v68, v16, v17
    v_cvt_pk_bf16_f32 v69, v18, v19
    buffer_store_dwordx2 v[68:69], v154, s[28:31], s20 offen offset:0 sc1
    v_cvt_pk_bf16_f32 v70, v20, v21
    v_cvt_pk_bf16_f32 v71, v22, v23
    buffer_store_dwordx2 v[70:71], v154, s[28:31], s20 offen offset:1024 sc1
    v_cvt_pk_bf16_f32 v72, v24, v25
    v_cvt_pk_bf16_f32 v73, v26, v27
    buffer_store_dwordx2 v[72:73], v154, s[28:31], s20 offen offset:2048 sc1
    v_cvt_pk_bf16_f32 v74, v28, v29
    v_cvt_pk_bf16_f32 v75, v30, v31
    buffer_store_dwordx2 v[74:75], v154, s[28:31], s20 offen offset:3072 sc1
K1FS_11:
    s_cmp_eq_u32 s60, 3
    s_cbranch_scc1 K1FS_12
    s_lshl_b32 s20, s63, 1
    s_lshr_b32 s21, s46, 1
    s_add_u32 s20, s20, s21
    s_mul_i32 s20, s20, 33792
    s_add_u32 s20, s20, s22
    v_cvt_pk_bf16_f32 v68, v32, v33
    v_cvt_pk_bf16_f32 v69, v34, v35
    buffer_store_dwordx2 v[68:69], v154, s[28:31], s20 offen offset:0 sc1
    v_cvt_pk_bf16_f32 v70, v36, v37
    v_cvt_pk_bf16_f32 v71, v38, v39
    buffer_store_dwordx2 v[70:71], v154, s[28:31], s20 offen offset:1024 sc1
    v_cvt_pk_bf16_f32 v72, v40, v41
    v_cvt_pk_bf16_f32 v73, v42, v43
    buffer_store_dwordx2 v[72:73], v154, s[28:31], s20 offen offset:2048 sc1
    v_cvt_pk_bf16_f32 v74, v44, v45
    v_cvt_pk_bf16_f32 v75, v46, v47
    buffer_store_dwordx2 v[74:75], v154, s[28:31], s20 offen offset:3072 sc1
K1FS_12:
    s_branch K1_FIN
K1EPI_8:
    s_waitcnt lgkmcnt(0)
    s_barrier
    ds_read_b64 v[80:81], v161 offset:0
    ds_read_b64 v[82:83], v161 offset:128
    ds_read_b64 v[84:85], v161 offset:256
    ds_read_b64 v[86:87], v161 offset:384
    ds_read_b128 v[56:59], v160 offset:1024
    ds_read_b128 v[68:71], v160 offset:1792
    ds_read_b128 v[60:63], v160 offset:1088
    ds_read_b128 v[72:75], v160 offset:1856
    ds_read_b128 v[64:67], v160 offset:1152
    ds_read_b128 v[76:79], v160 offset:1920
    s_lshl_b32 s57, s47, 2
    s_lshl_b32 s20, s45, 1
    s_add_u32 s57, s57, s20
    v_mov_b32 v116, 0xc0135761
    v_mov_b32 v117, 0xc0135761
    v_mov_b32 v118, 0xbdd2d3e8
    v_mov_b32 v119, 0xbdd2d3e8
    v_mov_b32 v120, 0x3f800000
    v_mov_b32 v121, 0x3f800000
    s_waitcnt lgkmcnt(0)
    v_add_f32 v56, v56, v68
    v_add_f32 v57, v57, v69
    v_add_f32 v58, v58, v70
    v_add_f32 v59, v59, v71
    v_add_f32 v60, v60, v72
    v_add_f32 v61, v61, v73
    v_add_f32 v62, v62, v74
    v_add_f32 v63, v63, v75
    v_add_f32 v64, v64, v76
    v_add_f32 v65, v65, v77
    v_add_f32 v66, v66, v78
    v_add_f32 v67, v67, v79
    v_and_b32 v152, 15, v151
    v_lshrrev_b32 v153, 4, v151
    s_cmp_eq_u32 s58, 3
    s_cbranch_scc1 K1N_13
    v_pk_fma_f32 v[0:1], v[80:81], v[56:57], v[0:1] op_sel_hi:[0,1,1]
    v_pk_fma_f32 v[2:3], v[80:81], v[58:59], v[2:3] op_sel_hi:[0,1,1]
    v_pk_fma_f32 v[4:5], v[82:83], v[56:57], v[4:5] op_sel_hi:[0,1,1]
    v_pk_fma_f32 v[6:7], v[82:83], v[58:59], v[6:7] op_sel_hi:[0,1,1]
    v_pk_fma_f32 v[8:9], v[84:85], v[56:57], v[8:9] op_sel_hi:[0,1,1]
    v_pk_fma_f32 v[10:11], v[84:85], v[58:59], v[10:11] op_sel_hi:[0,1,1]
    v_pk_fma_f32 v[12:13], v[86:87], v[56:57], v[12:13] op_sel_hi:[0,1,1]
    v_pk_fma_f32 v[14:15], v[86:87], v[58:59], v[14:15] op_sel_hi:[0,1,1]
    v_pk_mul_f32 v[0:1], v[0:1], v[80:81] op_sel:[0,1] op_sel_hi:[1,1]
    v_pk_mul_f32 v[2:3], v[2:3], v[80:81] op_sel:[0,1] op_sel_hi:[1,1]
    v_pk_mul_f32 v[4:5], v[4:5], v[82:83] op_sel:[0,1] op_sel_hi:[1,1]
    v_pk_mul_f32 v[6:7], v[6:7], v[82:83] op_sel:[0,1] op_sel_hi:[1,1]
    v_pk_mul_f32 v[8:9], v[8:9], v[84:85] op_sel:[0,1] op_sel_hi:[1,1]
    v_pk_mul_f32 v[10:11], v[10:11], v[84:85] op_sel:[0,1] op_sel_hi:[1,1]
    v_pk_mul_f32 v[12:13], v[12:13], v[86:87] op_sel:[0,1] op_sel_hi:[1,1]
    v_pk_mul_f32 v[14:15], v[14:15], v[86:87] op_sel:[0,1] op_sel_hi:[1,1]
K1FS_15:
    s_lshr_b32 s20, s61, 3
    s_mul_i32 s20, s20, 2162688
    s_and_b32 s21, s61, 7
    s_lshl_b32 s21, s21, 2
    s_add_u32 s21, s21, s46
    s_lshl_b32 s21, s21, 10
    s_add_u32 s20, s20, s21
    s_mul_i32 s21, s57, 33792
    s_add_u32 s20, s20, s21
    v_cvt_pk_bf16_f32 v92, v0, v1
    v_cvt_pk_bf16_f32 v93, v2, v3
    v_cvt_pk_bf16_f32 v94, v4, v5
    v_cvt_pk_bf16_f32 v95, v6, v7
    s_nop 0
    v_permlane16_swap_b32 v92, v94
    v_permlane16_swap_b32 v93, v95
    buffer_store_dwordx4 v[92:95], v162, s[28:31], s20 offen sc1
    v_cvt_pk_bf16_f32 v96, v8, v9
    v_cvt_pk_bf16_f32 v97, v10, v11
    v_cvt_pk_bf16_f32 v98, v12, v13
    v_cvt_pk_bf16_f32 v99, v14, v15
    s_nop 0
    v_permlane16_swap_b32 v96, v98
    v_permlane16_swap_b32 v97, v99
    s_add_u32 s20, s20, 33792
    buffer_store_dwordx4 v[96:99], v162, s[28:31], s20 offen sc1
K1N_13:
    v_pk_fma_f32 v[16:17], v[80:81], v[60:61], v[16:17] op_sel_hi:[0,1,1]
    v_pk_fma_f32 v[18:19], v[80:81], v[62:63], v[18:19] op_sel_hi:[0,1,1]
    v_pk_fma_f32 v[20:21], v[82:83], v[60:61], v[20:21] op_sel_hi:[0,1,1]
    v_pk_fma_f32 v[22:23], v[82:83], v[62:63], v[22:23] op_sel_hi:[0,1,1]
    v_pk_fma_f32 v[24:25], v[84:85], v[60:61], v[24:25] op_sel_hi:[0,1,1]
    v_pk_fma_f32 v[26:27], v[84:85], v[62:63], v[26:27] op_sel_hi:[0,1,1]
    v_pk_fma_f32 v[28:29], v[86:87], v[60:61], v[28:29] op_sel_hi:[0,1,1]
    v_pk_fma_f32 v[30:31], v[86:87], v[62:63], v[30:31] op_sel_hi:[0,1,1]
    v_pk_mul_f32 v[16:17], v[16:17], v[80:81] op_sel:[0,1] op_sel_hi:[1,1]
    v_pk_mul_f32 v[18:19], v[18:19], v[80:81] op_sel:[0,1] op_sel_hi:[1,1]
    v_pk_mul_f32 v[20:21], v[20:21], v[82:83] op_sel:[0,1] op_sel_hi:[1,1]
    v_pk_mul_f32 v[22:23], v[22:23], v[82:83] op_sel:[0,1] op_sel_hi:[1,1]
    v_pk_mul_f32 v[24:25], v[24:25], v[84:85] op_sel:[0,1] op_sel_hi:[1,1]
    v_pk_mul_f32 v[26:27], v[26:27], v[84:85] op_sel:[0,1] op_sel_hi:[1,1]
    v_pk_mul_f32 v[28:29], v[28:29], v[86:87] op_sel:[0,1] op_sel_hi:[1,1]
    v_pk_mul_f32 v[30:31], v[30:31], v[86:87] op_sel:[0,1] op_sel_hi:[1,1]
    s_cmp_eq_u32 s59, 0
    s_cbranch_scc1 K1FS_18
    v_pk_mul_f32 v[108:109], v[16:17], v[16:17]
    v_pk_mul_f32 v[110:111], v[18:19], v[18:19]
    v_pk_mul_f32 v[112:113], v[20:21], v[20:21]
    v_pk_mul_f32 v[114:115], v[22:23], v[22:23]
    v_pk_fma_f32 v[108:109], v[108:109], v[118:119], v[116:117]
    v_pk_fma_f32 v[110:111], v[110:111], v[118:119], v[116:117]
    v_pk_fma_f32 v[112:113], v[112:113], v[118:119], v[116:117]
    v_pk_fma_f32 v[114:115], v[114:115], v[118:119], v[116:117]
    v_pk_mul_f32 v[108:109], v[108:109], v[16:17]
    v_pk_mul_f32 v[110:111], v[110:111], v[18:19]
    v_pk_mul_f32 v[112:113], v[112:113], v[20:21]
    v_pk_mul_f32 v[114:115], v[114:115], v[22:23]
    v_exp_f32 v108, v108
    v_exp_f32 v109, v109
    v_exp_f32 v110, v110
    v_exp_f32 v111, v111
    v_exp_f32 v112, v112
    v_exp_f32 v113, v113
    v_exp_f32 v114, v114
    v_exp_f32 v115, v115
    v_pk_add_f32 v[108:109], v[108:109], v[120:121]
    v_pk_add_f32 v[110:111], v[110:111], v[120:121]
    v_pk_add_f32 v[112:113], v[112:113], v[120:121]
    v_pk_add_f32 v[114:115], v[114:115], v[120:121]
    v_rcp_f32 v108, v108
    v_rcp_f32 v109, v109
    v_rcp_f32 v110, v110
    v_rcp_f32 v111, v111
    v_rcp_f32 v112, v112
    v_rcp_f32 v113, v113
    v_rcp_f32 v114, v114
    v_rcp_f32 v115, v115
    v_pk_mul_f32 v[16:17], v[16:17], v[108:109]
    v_pk_mul_f32 v[18:19], v[18:19], v[110:111]
    v_pk_mul_f32 v[20:21], v[20:21], v[112:113]
    v_pk_mul_f32 v[22:23], v[22:23], v[114:115]
    v_pk_mul_f32 v[108:109], v[24:25], v[24:25]
    v_pk_mul_f32 v[110:111], v[26:27], v[26:27]
    v_pk_mul_f32 v[112:113], v[28:29], v[28:29]
    v_pk_mul_f32 v[114:115], v[30:31], v[30:31]
    v_pk_fma_f32 v[108:109], v[108:109], v[118:119], v[116:117]
    v_pk_fma_f32 v[110:111], v[110:111], v[118:119], v[116:117]
    v_pk_fma_f32 v[112:113], v[112:113], v[118:119], v[116:117]
    v_pk_fma_f32 v[114:115], v[114:115], v[118:119], v[116:117]
    v_pk_mul_f32 v[108:109], v[108:109], v[24:25]
    v_pk_mul_f32 v[110:111], v[110:111], v[26:27]
    v_pk_mul_f32 v[112:113], v[112:113], v[28:29]
    v_pk_mul_f32 v[114:115], v[114:115], v[30:31]
    v_exp_f32 v108, v108
    v_exp_f32 v109, v109
    v_exp_f32 v110, v110
    v_exp_f32 v111, v111
    v_exp_f32 v112, v112
    v_exp_f32 v113, v113
    v_exp_f32 v114, v114
    v_exp_f32 v115, v115
    v_pk_add_f32 v[108:109], v[108:109], v[120:121]
    v_pk_add_f32 v[110:111], v[110:111], v[120:121]
    v_pk_add_f32 v[112:113], v[112:113], v[120:121]
    v_pk_add_f32 v[114:115], v[114:115], v[120:121]
    v_rcp_f32 v108, v108
    v_rcp_f32 v109, v109
    v_rcp_f32 v110, v110
    v_rcp_f32 v111, v111
    v_rcp_f32 v112, v112
    v_rcp_f32 v113, v113
    v_rcp_f32 v114, v114
    v_rcp_f32 v115, v115
    v_pk_mul_f32 v[24:25], v[24:25], v[108:109]
    v_pk_mul_f32 v[26:27], v[26:27], v[110:111]
    v_pk_mul_f32 v[28:29], v[28:29], v[112:113]
    v_pk_mul_f32 v[30:31], v[30:31], v[114:115]
K1FS_18:
    s_lshr_b32 s20, s62, 3
    s_mul_i32 s20, s20, 2162688
    s_and_b32 s21, s62, 7
    s_lshl_b32 s21, s21, 2
    s_add_u32 s21, s21, s46
    s_lshl_b32 s21, s21, 10
    s_add_u32 s20, s20, s21
    s_mul_i32 s21, s57, 33792
    s_add_u32 s20, s20, s21
    v_cvt_pk_bf16_f32 v92, v16, v17
    v_cvt_pk_bf16_f32 v93, v18, v19
    v_cvt_pk_bf16_f32 v94, v20, v21
    v_cvt_pk_bf16_f32 v95, v22, v23
    s_nop 0
    v_permlane16_swap_b32 v92, v94
    v_permlane16_swap_b32 v93, v95
    buffer_store_dwordx4 v[92:95], v162, s[28:31], s20 offen sc1
    v_cvt_pk_bf16_f32 v96, v24, v25
    v_cvt_pk_bf16_f32 v97, v26, v27
    v_cvt_pk_bf16_f32 v98, v28, v29
    v_cvt_pk_bf16_f32 v99, v30, v31
    s_nop 0
    v_permlane16_swap_b32 v96, v98
    v_permlane16_swap_b32 v97, v99
    s_add_u32 s20, s20, 33792
    buffer_store_dwordx4 v[96:99], v162, s[28:31], s20 offen sc1
K1N_16:
    v_pk_fma_f32 v[32:33], v[80:81], v[64:65], v[32:33] op_sel_hi:[0,1,1]
    v_pk_fma_f32 v[34:35], v[80:81], v[66:67], v[34:35] op_sel_hi:[0,1,1]
    v_pk_fma_f32 v[36:37], v[82:83], v[64:65], v[36:37] op_sel_hi:[0,1,1]
    v_pk_fma_f32 v[38:39], v[82:83], v[66:67], v[38:39] op_sel_hi:[0,1,1]
    v_pk_fma_f32 v[40:41], v[84:85], v[64:65], v[40:41] op_sel_hi:[0,1,1]
    v_pk_fma_f32 v[42:43], v[84:85], v[66:67], v[42:43] op_sel_hi:[0,1,1]
    v_pk_fma_f32 v[44:45], v[86:87], v[64:65], v[44:45] op_sel_hi:[0,1,1]
    v_pk_fma_f32 v[46:47], v[86:87], v[66:67], v[46:47] op_sel_hi:[0,1,1]
    v_pk_mul_f32 v[32:33], v[32:33], v[80:81] op_sel:[0,1] op_sel_hi:[1,1]
    v_pk_mul_f32 v[34:35], v[34:35], v[80:81] op_sel:[0,1] op_sel_hi:[1,1]
    v_pk_mul_f32 v[36:37], v[36:37], v[82:83] op_sel:[0,1] op_sel_hi:[1,1]
    v_pk_mul_f32 v[38:39], v[38:39], v[82:83] op_sel:[0,1] op_sel_hi:[1,1]
    v_pk_mul_f32 v[40:41], v[40:41], v[84:85] op_sel:[0,1] op_sel_hi:[1,1]
    v_pk_mul_f32 v[42:43], v[42:43], v[84:85] op_sel:[0,1] op_sel_hi:[1,1]
    v_pk_mul_f32 v[44:45], v[44:45], v[86:87] op_sel:[0,1] op_sel_hi:[1,1]
    v_pk_mul_f32 v[46:47], v[46:47], v[86:87] op_sel:[0,1] op_sel_hi:[1,1]
    v_pk_mul_f32 v[108:109], v[32:33], v[32:33]
    v_pk_mul_f32 v[110:111], v[34:35], v[34:35]
    v_pk_mul_f32 v[112:113], v[36:37], v[36:37]
    v_pk_mul_f32 v[114:115], v[38:39], v[38:39]
    v_pk_fma_f32 v[108:109], v[108:109], v[118:119], v[116:117]
    v_pk_fma_f32 v[110:111], v[110:111], v[118:119], v[116:117]
    v_pk_fma_f32 v[112:113], v[112:113], v[118:119], v[116:117]
    v_pk_fma_f32 v[114:115], v[114:115], v[118:119], v[116:117]
    v_pk_mul_f32 v[108:109], v[108:109], v[32:33]
    v_pk_mul_f32 v[110:111], v[110:111], v[34:35]
    v_pk_mul_f32 v[112:113], v[112:113], v[36:37]
    v_pk_mul_f32 v[114:115], v[114:115], v[38:39]
    v_exp_f32 v108, v108
    v_exp_f32 v109, v109
    v_exp_f32 v110, v110
    v_exp_f32 v111, v111
    v_exp_f32 v112, v112
    v_exp_f32 v113, v113
    v_exp_f32 v114, v114
    v_exp_f32 v115, v115
    v_pk_add_f32 v[108:109], v[108:109], v[120:121]
    v_pk_add_f32 v[110:111], v[110:111], v[120:121]
    v_pk_add_f32 v[112:113], v[112:113], v[120:121]
    v_pk_add_f32 v[114:115], v[114:115], v[120:121]
    v_rcp_f32 v108, v108
    v_rcp_f32 v109, v109
    v_rcp_f32 v110, v110
    v_rcp_f32 v111, v111
    v_rcp_f32 v112, v112
    v_rcp_f32 v113, v113
    v_rcp_f32 v114, v114
    v_rcp_f32 v115, v115
    v_pk_mul_f32 v[32:33], v[32:33], v[108:109]
    v_pk_mul_f32 v[34:35], v[34:35], v[110:111]
    v_pk_mul_f32 v[36:37], v[36:37], v[112:113]
    v_pk_mul_f32 v[38:39], v[38:39], v[114:115]
    v_pk_mul_f32 v[108:109], v[40:41], v[40:41]
    v_pk_mul_f32 v[110:111], v[42:43], v[42:43]
    v_pk_mul_f32 v[112:113], v[44:45], v[44:45]
    v_pk_mul_f32 v[114:115], v[46:47], v[46:47]
    v_pk_fma_f32 v[108:109], v[108:109], v[118:119], v[116:117]
    v_pk_fma_f32 v[110:111], v[110:111], v[118:119], v[116:117]
    v_pk_fma_f32 v[112:113], v[112:113], v[118:119], v[116:117]
    v_pk_fma_f32 v[114:115], v[114:115], v[118:119], v[116:117]
    v_pk_mul_f32 v[108:109], v[108:109], v[40:41]
    v_pk_mul_f32 v[110:111], v[110:111], v[42:43]
    v_pk_mul_f32 v[112:113], v[112:113], v[44:45]
    v_pk_mul_f32 v[114:115], v[114:115], v[46:47]
    v_exp_f32 v108, v108
    v_exp_f32 v109, v109
    v_exp_f32 v110, v110
    v_exp_f32 v111, v111
    v_exp_f32 v112, v112
    v_exp_f32 v113, v113
    v_exp_f32 v114, v114
    v_exp_f32 v115, v115
    v_pk_add_f32 v[108:109], v[108:109], v[120:121]
    v_pk_add_f32 v[110:111], v[110:111], v[120:121]
    v_pk_add_f32 v[112:113], v[112:113], v[120:121]
    v_pk_add_f32 v[114:115], v[114:115], v[120:121]
    v_rcp_f32 v108, v108
    v_rcp_f32 v109, v109
    v_rcp_f32 v110, v110
    v_rcp_f32 v111, v111
    v_rcp_f32 v112, v112
    v_rcp_f32 v113, v113
    v_rcp_f32 v114, v114
    v_rcp_f32 v115, v115
    v_pk_mul_f32 v[40:41], v[40:41], v[108:109]
    v_pk_mul_f32 v[42:43], v[42:43], v[110:111]
    v_pk_mul_f32 v[44:45], v[44:45], v[112:113]
    v_pk_mul_f32 v[46:47], v[46:47], v[114:115]
    s_cmp_eq_u32 s60, 2
    s_cbranch_scc1 K1G_20
K1FS_21:
    s_lshr_b32 s20, s63, 3
    s_mul_i32 s20, s20, 2162688
    s_and_b32 s21, s63, 7
    s_lshl_b32 s21, s21, 2
    s_add_u32 s21, s21, s46
    s_lshl_b32 s21, s21, 10
    s_add_u32 s20, s20, s21
    s_mul_i32 s21, s57, 33792
    s_add_u32 s20, s20, s21
    v_cvt_pk_bf16_f32 v92, v32, v33
    v_cvt_pk_bf16_f32 v93, v34, v35
    v_cvt_pk_bf16_f32 v94, v36, v37
    v_cvt_pk_bf16_f32 v95, v38, v39
    s_nop 0
    v_permlane16_swap_b32 v92, v94
    v_permlane16_swap_b32 v93, v95
    buffer_store_dwordx4 v[92:95], v162, s[28:31], s20 offen sc1
    v_cvt_pk_bf16_f32 v96, v40, v41
    v_cvt_pk_bf16_f32 v97, v42, v43
    v_cvt_pk_bf16_f32 v98, v44, v45
    v_cvt_pk_bf16_f32 v99, v46, v47
    s_nop 0
    v_permlane16_swap_b32 v96, v98
    v_permlane16_swap_b32 v97, v99
    s_add_u32 s20, s20, 33792
    buffer_store_dwordx4 v[96:99], v162, s[28:31], s20 offen sc1
    s_branch K1N_19
K1G_20:
    s_and_b32 s22, s63, 7
    s_lshl_b32 s23, s22, 14
    s_add_u32 s23, s23, 12910592
    s_lshl_b32 s20, s47, 7
    s_lshl_b32 s21, s44, 4
    s_add_u32 s20, s20, s21
    s_lshl_b32 s20, s20, 10
    s_lshl_b32 s21, s22, 7
    s_add_u32 s20, s20, s21
    s_add_u32 s20, s20, 10813440
    v_pk_add_f32 v[108:109], v[32:33], v[34:35]
    v_pk_mul_f32 v[110:111], v[32:33], v[32:33]
    v_pk_fma_f32 v[110:111], v[34:35], v[34:35], v[110:111]
    v_pk_add_f32 v[112:113], v[36:37], v[38:39]
    v_pk_mul_f32 v[114:115], v[36:37], v[36:37]
    v_pk_fma_f32 v[114:115], v[38:39], v[38:39], v[114:115]
    v_add_f32 v100, v108, v109
    v_add_f32 v102, v110, v111
    v_add_f32 v101, v112, v113
    v_add_f32 v103, v114, v115
    v_cvt_pk_bf16_f32 v92, v32, v33
    v_cvt_pk_bf16_f32 v93, v34, v35
    v_cvt_pk_bf16_f32 v94, v36, v37
    v_cvt_pk_bf16_f32 v95, v38, v39
    s_nop 0
    v_permlane16_swap_b32 v92, v94
    v_permlane16_swap_b32 v93, v95
    ds_write_b128 v163, v[92:95] offset:8192
    v_permlane16_swap_b32 v100, v101
    v_permlane16_swap_b32 v102, v103
    v_add_f32 v100, v100, v101
    v_add_f32 v102, v102, v103
    s_nop 1
    v_permlane32_swap_b32 v100, v102
    v_add_f32 v100, v100, v102
    ds_write_b32 v164, v100 offset:4096
    v_pk_add_f32 v[108:109], v[40:41], v[42:43]
    v_pk_mul_f32 v[110:111], v[40:41], v[40:41]
    v_pk_fma_f32 v[110:111], v[42:43], v[42:43], v[110:111]
    v_pk_add_f32 v[112:113], v[44:45], v[46:47]
    v_pk_mul_f32 v[114:115], v[44:45], v[44:45]
    v_pk_fma_f32 v[114:115], v[46:47], v[46:47], v[114:115]
    v_add_f32 v100, v108, v109
    v_add_f32 v102, v110, v111
    v_add_f32 v101, v112, v113
    v_add_f32 v103, v114, v115
    v_cvt_pk_bf16_f32 v96, v40, v41
    v_cvt_pk_bf16_f32 v97, v42, v43
    v_cvt_pk_bf16_f32 v98, v44, v45
    v_cvt_pk_bf16_f32 v99, v46, v47
    s_nop 0
    v_permlane16_swap_b32 v96, v98
    v_permlane16_swap_b32 v97, v99
    ds_write_b128 v163, v[96:99] offset:12288
    v_permlane16_swap_b32 v100, v101
    v_permlane16_swap_b32 v102, v103
    v_add_f32 v100, v100, v101
    v_add_f32 v102, v102, v103
    s_nop 1
    v_permlane32_swap_b32 v100, v102
    v_add_f32 v100, v100, v102
    ds_write_b32 v164, v100 offset:4352
    s_waitcnt lgkmcnt(0)
    s_barrier
    ds_read_b128 v[92:95], v168 offset:8192
    ds_read_b128 v[96:99], v168 offset:9216
    s_cmp_ge_u32 s44, 4
    s_cbranch_scc1 K1GK_22
    ds_read_b32 v100, v169 offset:4096
    ds_read_b32 v101, v169 offset:5120
    ds_read_b32 v102, v169 offset:6144
    ds_read_b32 v103, v169 offset:7168
    s_lshl_b32 s21, s47, 10
    s_add_u32 s21, s21, s23
    s_waitcnt lgkmcnt(0)
    v_add_f32 v100, v100, v101
    v_add_f32 v102, v102, v103
    v_add_f32 v100, v100, v102
    buffer_store_dword v100, v169, s[28:31], s21 offen sc1
K1GK_22:
    s_waitcnt lgkmcnt(0)
    buffer_store_dwordx4 v[92:95], v167, s[28:31], s20 offen sc1
    s_add_u32 s20, s20, 8192
    buffer_store_dwordx4 v[96:99], v167, s[28:31], s20 offen sc1
K1N_19:
K1_FIN:
K1_END:
    s_endpgm
.globl k2_kernel
.p2align 8
.type k2_kernel,@function
k2_kernel:
    s_cmp_ge_u32 s2, 256
    s_cbranch_scc1 K2_END
    s_load_dwordx2 s[4:5], s[0:1], 88
    s_load_dwordx2 s[6:7], s[0:1], 48
    s_load_dwordx2 s[34:35], s[0:1], 0
    v_lshrrev_b32 v2, 6, v0
    v_and_b32 v0, 63, v0
    v_readfirstlane_b32 s16, v2
    s_and_b32 s17, s2, 7
    s_lshr_b32 s18, s2, 3
    s_cmp_ge_u32 s18, 24
    s_cbranch_scc1 K2_CONV
    s_cmp_ge_u32 s16, 4
    s_cbranch_scc1 K2_END
    s_cmp_ge_u32 s18, 16
    s_cbranch_scc1 K2V_1
    s_mov_b32 s26, 0
    s_lshr_b32 s19, s17, 2
    s_lshl_b32 s19, s19, 5
    s_and_b32 s25, s17, 1
    s_lshl_b32 s25, s25, 2
    s_lshr_b32 s20, s18, 2
    s_add_u32 s25, s25, s20
    s_lshr_b32 s20, s17, 1
    s_and_b32 s20, s20, 1
    s_lshl_b32 s20, s20, 2
    s_and_b32 s21, s18, 3
    s_add_u32 s20, s20, s21
    s_lshl_b32 s20, s20, 2
    s_add_u32 s20, s20, s19
    s_add_u32 s20, s20, s16
    s_lshl_b32 s22, s25, 2
    s_add_u32 s22, s22, s19
    s_mul_i32 s22, s22, 33792
    s_add_u32 s22, s22, 2162688
    s_mul_i32 s23, s20, 33792
    s_add_u32 s23, s23, 0
    s_mul_i32 s24, s20, 66560
    s_lshl_b32 s21, s25, 13
    s_add_u32 s24, s24, s21
    s_add_u32 s24, s24, 14254080
    s_lshl_b32 s30, s20, 3
    s_add_u32 s30, s30, s25
    s_lshl_b32 s30, s30, 8
    s_add_u32 s30, s30, 14123008
    s_branch K2J_2
K2V_1:
    s_mov_b32 s26, 1
    s_sub_u32 s21, s18, 16
    s_lshr_b32 s19, s21, 2
    s_lshl_b32 s20, s17, 1
    s_add_u32 s19, s19, s20
    s_and_b32 s25, s19, 7
    s_mul_i32 s22, s19, 135168
    s_add_u32 s22, s22, 4325376
    s_and_b32 s21, s21, 3
    s_lshl_b32 s21, s21, 2
    s_add_u32 s21, s21, s16
    s_mul_i32 s23, s21, 33792
    s_add_u32 s23, s23, 13041664
    s_lshr_b32 s19, s19, 3
    s_lshl_b32 s19, s19, 4
    s_add_u32 s19, s19, s21
    s_mul_i32 s24, s19, 66560
    s_lshl_b32 s21, s25, 13
    s_add_u32 s24, s24, s21
    s_add_u32 s24, s24, 18513920
K2J_2:
    v_lshlrev_b32 v8, 4, v0
    v_mov_b32 v9, v8
    v_add_u32 v10, 65536, v8
    s_lshl_b32 s27, s16, 15
    s_mul_i32 s28, s16, 33792
    s_add_u32 s28, s28, s22
    s_mov_b32 s29, s23
    s_waitcnt lgkmcnt(0)
    s_mov_b32 s8, s4
    s_mov_b32 s9, s5
    s_mov_b32 s10, 20643840
    s_mov_b32 s11, 131072
    s_add_u32 m0, s27, 0
    s_nop 0
    buffer_load_dwordx4 v8, s[8:11], s28 offen offset:0 lds
    buffer_load_dwordx4 v[64:67], v8, s[8:11], s29 offen offset:0
    buffer_load_dwordx4 v8, s[8:11], s28 offen offset:1024 lds
    buffer_load_dwordx4 v[68:71], v8, s[8:11], s29 offen offset:1024
    buffer_load_dwordx4 v8, s[8:11], s28 offen offset:2048 lds
    buffer_load_dwordx4 v[72:75], v8, s[8:11], s29 offen offset:2048
    buffer_load_dwordx4 v8, s[8:11], s28 offen offset:3072 lds
    buffer_load_dwordx4 v[76:79], v8, s[8:11], s29 offen offset:3072
    s_add_u32 s28, s28, 4096
    s_add_u32 s29, s29, 4096
    s_add_u32 m0, s27, 4096
    s_nop 0
    buffer_load_dwordx4 v8, s[8:11], s28 offen offset:0 lds
    buffer_load_dwordx4 v[80:83], v8, s[8:11], s29 offen offset:0
    buffer_load_dwordx4 v8, s[8:11], s28 offen offset:1024 lds
    buffer_load_dwordx4 v[84:87], v8, s[8:11], s29 offen offset:1024
    buffer_load_dwordx4 v8, s[8:11], s28 offen offset:2048 lds
    buffer_load_dwordx4 v[88:91], v8, s[8:11], s29 offen offset:2048
    buffer_load_dwordx4 v8, s[8:11], s28 offen offset:3072 lds
    buffer_load_dwordx4 v[92:95], v8, s[8:11], s29 offen offset:3072
    s_add_u32 s28, s28, 4096
    s_add_u32 s29, s29, 4096
    s_add_u32 m0, s27, 8192
    s_nop 0
    buffer_load_dwordx4 v8, s[8:11], s28 offen offset:0 lds
    buffer_load_dwordx4 v[96:99], v8, s[8:11], s29 offen offset:0
    s_waitcnt vmcnt(14)
    s_barrier
    ds_read_b128 v[32:35], v9 offset:0
    ds_read_b128 v[36:39], v9 offset:32768
    ds_read_b128 v[40:43], v10 offset:0
    ds_read_b128 v[44:47], v10 offset:32768
    ds_read_b128 v[48:51], v9 offset:1024
    ds_read_b128 v[52:55], v9 offset:33792
    ds_read_b128 v[56:59], v10 offset:1024
    ds_read_b128 v[60:63], v10 offset:33792
    s_waitcnt lgkmcnt(4)
    v_mfma_f32_32x32x16_bf16 v[192:207], v[32:35], v[64:67], 0
    buffer_load_dwordx4 v8, s[8:11], s28 offen offset:1024 lds
    buffer_load_dwordx4 v[100:103], v8, s[8:11], s29 offen offset:1024
    v_mfma_f32_32x32x16_bf16 v[208:223], v[36:39], v[64:67], 0
    v_mfma_f32_32x32x16_bf16 v[224:239], v[40:43], v[64:67], 0
    v_mfma_f32_32x32x16_bf16 v[240:255], v[44:47], v[64:67], 0
    s_waitcnt vmcnt(12)
    s_barrier
    ds_read_b128 v[32:35], v9 offset:2048
    ds_read_b128 v[36:39], v9 offset:34816
    ds_read_b128 v[40:43], v10 offset:2048
    ds_read_b128 v[44:47], v10 offset:34816
    s_waitcnt lgkmcnt(4)
    v_mfma_f32_32x32x16_bf16 v[192:207], v[48:51], v[68:71], v[192:207]
    buffer_load_dwordx4 v8, s[8:11], s28 offen offset:2048 lds
    buffer_load_dwordx4 v[104:107], v8, s[8:11], s29 offen offset:2048
    v_mfma_f32_32x32x16_bf16 v[208:223], v[52:55], v[68:71], v[208:223]
    v_mfma_f32_32x32x16_bf16 v[224:239], v[56:59], v[68:71], v[224:239]
    v_mfma_f32_32x32x16_bf16 v[240:255], v[60:63], v[68:71], v[240:255]
    ds_read_b128 v[48:51], v9 offset:3072
    ds_read_b128 v[52:55], v9 offset:35840
    ds_read_b128 v[56:59], v10 offset:3072
    ds_read_b128 v[60:63], v10 offset:35840
    s_waitcnt lgkmcnt(4)
    v_mfma_f32_32x32x16_bf16 v[192:207], v[32:35], v[72:75], v[192:207]
    buffer_load_dwordx4 v8, s[8:11], s28 offen offset:3072 lds
    buffer_load_dwordx4 v[108:111], v8, s[8:11], s29 offen offset:3072
    s_add_u32 s28, s28, 4096
    s_add_u32 s29, s29, 4096
    v_mfma_f32_32x32x16_bf16 v[208:223], v[36:39], v[72:75], v[208:223]
    v_mfma_f32_32x32x16_bf16 v[224:239], v[40:43], v[72:75], v[224:239]
    v_mfma_f32_32x32x16_bf16 v[240:255], v[44:47], v[72:75], v[240:255]
    s_waitcnt vmcnt(12)
    s_barrier
    ds_read_b128 v[32:35], v9 offset:4096
    ds_read_b128 v[36:39], v9 offset:36864
    ds_read_b128 v[40:43], v10 offset:4096
    ds_read_b128 v[44:47], v10 offset:36864
    s_waitcnt lgkmcnt(4)
    v_mfma_f32_32x32x16_bf16 v[192:207], v[48:51], v[76:79], v[192:207]
    s_add_u32 m0, s27, 12288
    s_nop 0
    buffer_load_dwordx4 v8, s[8:11], s28 offen offset:0 lds
    buffer_load_dwordx4 v[112:115], v8, s[8:11], s29 offen offset:0
    v_mfma_f32_32x32x16_bf16 v[208:223], v[52:55], v[76:79], v[208:223]
    v_mfma_f32_32x32x16_bf16 v[224:239], v[56:59], v[76:79], v[224:239]
    v_mfma_f32_32x32x16_bf16 v[240:255], v[60:63], v[76:79], v[240:255]
    ds_read_b128 v[48:51], v9 offset:5120
    ds_read_b128 v[52:55], v9 offset:37888
    ds_read_b128 v[56:59], v10 offset:5120
    ds_read_b128 v[60:63], v10 offset:37888
    s_waitcnt lgkmcnt(4)
    v_mfma_f32_32x32x16_bf16 v[192:207], v[32:35], v[80:83], v[192:207]
    buffer_load_dwordx4 v8, s[8:11], s28 offen offset:1024 lds
    buffer_load_dwordx4 v[116:119], v8, s[8:11], s29 offen offset:1024
    v_mfma_f32_32x32x16_bf16 v[208:223], v[36:39], v[80:83], v[208:223]
    v_mfma_f32_32x32x16_bf16 v[224:239], v[40:43], v[80:83], v[224:239]
    v_mfma_f32_32x32x16_bf16 v[240:255], v[44:47], v[80:83], v[240:255]
    s_waitcnt vmcnt(12)
    s_barrier
    ds_read_b128 v[32:35], v9 offset:6144
    ds_read_b128 v[36:39], v9 offset:38912
    ds_read_b128 v[40:43], v10 offset:6144
    ds_read_b128 v[44:47], v10 offset:38912
    s_waitcnt lgkmcnt(4)
    v_mfma_f32_32x32x16_bf16 v[192:207], v[48:51], v[84:87], v[192:207]
    buffer_load_dwordx4 v8, s[8:11], s28 offen offset:2048 lds
    buffer_load_dwordx4 v[120:123], v8, s[8:11], s29 offen offset:2048
    v_mfma_f32_32x32x16_bf16 v[208:223], v[52:55], v[84:87], v[208:223]
    v_mfma_f32_32x32x16_bf16 v[224:239], v[56:59], v[84:87], v[224:239]
    v_mfma_f32_32x32x16_bf16 v[240:255], v[60:63], v[84:87], v[240:255]
    ds_read_b128 v[48:51], v9 offset:7168
    ds_read_b128 v[52:55], v9 offset:39936
    ds_read_b128 v[56:59], v10 offset:7168
    ds_read_b128 v[60:63], v10 offset:39936
    s_waitcnt lgkmcnt(4)
    v_mfma_f32_32x32x16_bf16 v[192:207], v[32:35], v[88:91], v[192:207]
    buffer_load_dwordx4 v8, s[8:11], s28 offen offset:3072 lds
    buffer_load_dwordx4 v[124:127], v8, s[8:11], s29 offen offset:3072
    s_add_u32 s28, s28, 4096
    s_add_u32 s29, s29, 4096
    v_mfma_f32_32x32x16_bf16 v[208:223], v[36:39], v[88:91], v[208:223]
    v_mfma_f32_32x32x16_bf16 v[224:239], v[40:43], v[88:91], v[224:239]
    v_mfma_f32_32x32x16_bf16 v[240:255], v[44:47], v[88:91], v[240:255]
    s_waitcnt vmcnt(12)
    s_barrier
    ds_read_b128 v[32:35], v9 offset:8192
    ds_read_b128 v[36:39], v9 offset:40960
    ds_read_b128 v[40:43], v10 offset:8192
    ds_read_b128 v[44:47], v10 offset:40960
    s_waitcnt lgkmcnt(4)
    v_mfma_f32_32x32x16_bf16 v[192:207], v[48:51], v[92:95], v[192:207]
    s_add_u32 m0, s27, 16384
    s_nop 0
    buffer_load_dwordx4 v8, s[8:11], s28 offen offset:0 lds
    buffer_load_dwordx4 v[128:131], v8, s[8:11], s29 offen offset:0
    v_mfma_f32_32x32x16_bf16 v[208:223], v[52:55], v[92:95], v[208:223]
    v_mfma_f32_32x32x16_bf16 v[224:239], v[56:59], v[92:95], v[224:239]
    v_mfma_f32_32x32x16_bf16 v[240:255], v[60:63], v[92:95], v[240:255]
    ds_read_b128 v[48:51], v9 offset:9216
    ds_read_b128 v[52:55], v9 offset:41984
    ds_read_b128 v[56:59], v10 offset:9216
    ds_read_b128 v[60:63], v10 offset:41984
    s_waitcnt lgkmcnt(4)
    v_mfma_f32_32x32x16_bf16 v[192:207], v[32:35], v[96:99], v[192:207]
    buffer_load_dwordx4 v8, s[8:11], s28 offen offset:1024 lds
    buffer_load_dwordx4 v[132:135], v8, s[8:11], s29 offen offset:1024
    v_mfma_f32_32x32x16_bf16 v[208:223], v[36:39], v[96:99], v[208:223]
    v_mfma_f32_32x32x16_bf16 v[224:239], v[40:43], v[96:99], v[224:239]
    v_mfma_f32_32x32x16_bf16 v[240:255], v[44:47], v[96:99], v[240:255]
    s_waitcnt vmcnt(12)
    s_barrier
    ds_read_b128 v[32:35], v9 offset:10240
    ds_read_b128 v[36:39], v9 offset:43008
    ds_read_b128 v[40:43], v10 offset:10240
    ds_read_b128 v[44:47], v10 offset:43008
    s_waitcnt lgkmcnt(4)
    v_mfma_f32_32x32x16_bf16 v[192:207], v[48:51], v[100:103], v[192:207]
    buffer_load_dwordx4 v8, s[8:11], s28 offen offset:2048 lds
    buffer_load_dwordx4 v[136:139], v8, s[8:11], s29 offen offset:2048
    v_mfma_f32_32x32x16_bf16 v[208:223], v[52:55], v[100:103], v[208:223]
    v_mfma_f32_32x32x16_bf16 v[224:239], v[56:59], v[100:103], v[224:239]
    v_mfma_f32_32x32x16_bf16 v[240:255], v[60:63], v[100:103], v[240:255]
    ds_read_b128 v[48:51], v9 offset:11264
    ds_read_b128 v[52:55], v9 offset:44032
    ds_read_b128 v[56:59], v10 offset:11264
    ds_read_b128 v[60:63], v10 offset:44032
    s_waitcnt lgkmcnt(4)
    v_mfma_f32_32x32x16_bf16 v[192:207], v[32:35], v[104:107], v[192:207]
    buffer_load_dwordx4 v8, s[8:11], s28 offen offset:3072 lds
    buffer_load_dwordx4 v[140:143], v8, s[8:11], s29 offen offset:3072
    s_add_u32 s28, s28, 4096
    s_add_u32 s29, s29, 4096
    v_mfma_f32_32x32x16_bf16 v[208:223], v[36:39], v[104:107], v[208:223]
    v_mfma_f32_32x32x16_bf16 v[224:239], v[40:43], v[104:107], v[224:239]
    v_mfma_f32_32x32x16_bf16 v[240:255], v[44:47], v[104:107], v[240:255]
    s_waitcnt vmcnt(12)
    s_barrier
    ds_read_b128 v[32:35], v9 offset:12288
    ds_read_b128 v[36:39], v9 offset:45056
    ds_read_b128 v[40:43], v10 offset:12288
    ds_read_b128 v[44:47], v10 offset:45056
    s_waitcnt lgkmcnt(4)
    v_mfma_f32_32x32x16_bf16 v[192:207], v[48:51], v[108:111], v[192:207]
    s_add_u32 m0, s27, 20480
    s_nop 0
    buffer_load_dwordx4 v8, s[8:11], s28 offen offset:0 lds
    buffer_load_dwordx4 v[144:147], v8, s[8:11], s29 offen offset:0
    v_mfma_f32_32x32x16_bf16 v[208:223], v[52:55], v[108:111], v[208:223]
    v_mfma_f32_32x32x16_bf16 v[224:239], v[56:59], v[108:111], v[224:239]
    v_mfma_f32_32x32x16_bf16 v[240:255], v[60:63], v[108:111], v[240:255]
    ds_read_b128 v[48:51], v9 offset:13312
    ds_read_b128 v[52:55], v9 offset:46080
    ds_read_b128 v[56:59], v10 offset:13312
    ds_read_b128 v[60:63], v10 offset:46080
    s_waitcnt lgkmcnt(4)
    v_mfma_f32_32x32x16_bf16 v[192:207], v[32:35], v[112:115], v[192:207]
    buffer_load_dwordx4 v8, s[8:11], s28 offen offset:1024 lds
    buffer_load_dwordx4 v[148:151], v8, s[8:11], s29 offen offset:1024
    v_mfma_f32_32x32x16_bf16 v[208:223], v[36:39], v[112:115], v[208:223]
    v_mfma_f32_32x32x16_bf16 v[224:239], v[40:43], v[112:115], v[224:239]
    v_mfma_f32_32x32x16_bf16 v[240:255], v[44:47], v[112:115], v[240:255]
    s_waitcnt vmcnt(12)
    s_barrier
    ds_read_b128 v[32:35], v9 offset:14336
    ds_read_b128 v[36:39], v9 offset:47104
    ds_read_b128 v[40:43], v10 offset:14336
    ds_read_b128 v[44:47], v10 offset:47104
    s_waitcnt lgkmcnt(4)
    v_mfma_f32_32x32x16_bf16 v[192:207], v[48:51], v[116:119], v[192:207]
    buffer_load_dwordx4 v8, s[8:11], s28 offen offset:2048 lds
    buffer_load_dwordx4 v[152:155], v8, s[8:11], s29 offen offset:2048
    v_mfma_f32_32x32x16_bf16 v[208:223], v[52:55], v[116:119], v[208:223]
    v_mfma_f32_32x32x16_bf16 v[224:239], v[56:59], v[116:119], v[224:239]
    v_mfma_f32_32x32x16_bf16 v[240:255], v[60:63], v[116:119], v[240:255]
    ds_read_b128 v[48:51], v9 offset:15360
    ds_read_b128 v[52:55], v9 offset:48128
    ds_read_b128 v[56:59], v10 offset:15360
    ds_read_b128 v[60:63], v10 offset:48128
    s_waitcnt lgkmcnt(4)
    v_mfma_f32_32x32x16_bf16 v[192:207], v[32:35], v[120:123], v[192:207]
    buffer_load_dwordx4 v8, s[8:11], s28 offen offset:3072 lds
    buffer_load_dwordx4 v[156:159], v8, s[8:11], s29 offen offset:3072
    s_add_u32 s28, s28, 4096
    s_add_u32 s29, s29, 4096
    v_mfma_f32_32x32x16_bf16 v[208:223], v[36:39], v[120:123], v[208:223]
    v_mfma_f32_32x32x16_bf16 v[224:239], v[40:43], v[120:123], v[224:239]
    v_mfma_f32_32x32x16_bf16 v[240:255], v[44:47], v[120:123], v[240:255]
    s_waitcnt vmcnt(12)
    s_barrier
    ds_read_b128 v[32:35], v9 offset:16384
    ds_read_b128 v[36:39], v9 offset:49152
    ds_read_b128 v[40:43], v10 offset:16384
    ds_read_b128 v[44:47], v10 offset:49152
    s_waitcnt lgkmcnt(4)
    v_mfma_f32_32x32x16_bf16 v[192:207], v[48:51], v[124:127], v[192:207]
    s_add_u32 m0, s27, 24576
    s_nop 0
    buffer_load_dwordx4 v8, s[8:11], s28 offen offset:0 lds
    buffer_load_dwordx4 v[160:163], v8, s[8:11], s29 offen offset:0
    v_mfma_f32_32x32x16_bf16 v[208:223], v[52:55], v[124:127], v[208:223]
    v_mfma_f32_32x32x16_bf16 v[224:239], v[56:59], v[124:127], v[224:239]
    v_mfma_f32_32x32x16_bf16 v[240:255], v[60:63], v[124:127], v[240:255]
    ds_read_b128 v[48:51], v9 offset:17408
    ds_read_b128 v[52:55], v9 offset:50176
    ds_read_b128 v[56:59], v10 offset:17408
    ds_read_b128 v[60:63], v10 offset:50176
    s_waitcnt lgkmcnt(4)
    v_mfma_f32_32x32x16_bf16 v[192:207], v[32:35], v[128:131], v[192:207]
    buffer_load_dwordx4 v8, s[8:11], s28 offen offset:1024 lds
    buffer_load_dwordx4 v[164:167], v8, s[8:11], s29 offen offset:1024
    v_mfma_f32_32x32x16_bf16 v[208:223], v[36:39], v[128:131], v[208:223]
    v_mfma_f32_32x32x16_bf16 v[224:239], v[40:43], v[128:131], v[224:239]
    v_mfma_f32_32x32x16_bf16 v[240:255], v[44:47], v[128:131], v[240:255]
    s_waitcnt vmcnt(12)
    s_barrier
    ds_read_b128 v[32:35], v9 offset:18432
    ds_read_b128 v[36:39], v9 offset:51200
    ds_read_b128 v[40:43], v10 offset:18432
    ds_read_b128 v[44:47], v10 offset:51200
    s_waitcnt lgkmcnt(4)
    v_mfma_f32_32x32x16_bf16 v[192:207], v[48:51], v[132:135], v[192:207]
    buffer_load_dwordx4 v8, s[8:11], s28 offen offset:2048 lds
    buffer_load_dwordx4 v[168:171], v8, s[8:11], s29 offen offset:2048
    v_mfma_f32_32x32x16_bf16 v[208:223], v[52:55], v[132:135], v[208:223]
    v_mfma_f32_32x32x16_bf16 v[224:239], v[56:59], v[132:135], v[224:239]
    v_mfma_f32_32x32x16_bf16 v[240:255], v[60:63], v[132:135], v[240:255]
    ds_read_b128 v[48:51], v9 offset:19456
    ds_read_b128 v[52:55], v9 offset:52224
    ds_read_b128 v[56:59], v10 offset:19456
    ds_read_b128 v[60:63], v10 offset:52224
    s_waitcnt lgkmcnt(4)
    v_mfma_f32_32x32x16_bf16 v[192:207], v[32:35], v[136:139], v[192:207]
    buffer_load_dwordx4 v8, s[8:11], s28 offen offset:3072 lds
    buffer_load_dwordx4 v[172:175], v8, s[8:11], s29 offen offset:3072
    s_add_u32 s28, s28, 4096
    s_add_u32 s29, s29, 4096
    v_mfma_f32_32x32x16_bf16 v[208:223], v[36:39], v[136:139], v[208:223]
    v_mfma_f32_32x32x16_bf16 v[224:239], v[40:43], v[136:139], v[224:239]
    v_mfma_f32_32x32x16_bf16 v[240:255], v[44:47], v[136:139], v[240:255]
    s_waitcnt vmcnt(12)
    s_barrier
    ds_read_b128 v[32:35], v9 offset:20480
    ds_read_b128 v[36:39], v9 offset:53248
    ds_read_b128 v[40:43], v10 offset:20480
    ds_read_b128 v[44:47], v10 offset:53248
    s_waitcnt lgkmcnt(4)
    v_mfma_f32_32x32x16_bf16 v[192:207], v[48:51], v[140:143], v[192:207]
    s_add_u32 m0, s27, 28672
    s_nop 0
    buffer_load_dwordx4 v8, s[8:11], s28 offen offset:0 lds
    buffer_load_dwordx4 v[176:179], v8, s[8:11], s29 offen offset:0
    v_mfma_f32_32x32x16_bf16 v[208:223], v[52:55], v[140:143], v[208:223]
    v_mfma_f32_32x32x16_bf16 v[224:239], v[56:59], v[140:143], v[224:239]
    v_mfma_f32_32x32x16_bf16 v[240:255], v[60:63], v[140:143], v[240:255]
    ds_read_b128 v[48:51], v9 offset:21504
    ds_read_b128 v[52:55], v9 offset:54272
    ds_read_b128 v[56:59], v10 offset:21504
    ds_read_b128 v[60:63], v10 offset:54272
    s_waitcnt lgkmcnt(4)
    v_mfma_f32_32x32x16_bf16 v[192:207], v[32:35], v[144:147], v[192:207]
    buffer_load_dwordx4 v8, s[8:11], s28 offen offset:1024 lds
    buffer_load_dwordx4 v[180:183], v8, s[8:11], s29 offen offset:1024
    v_mfma_f32_32x32x16_bf16 v[208:223], v[36:39], v[144:147], v[208:223]
    v_mfma_f32_32x32x16_bf16 v[224:239], v[40:43], v[144:147], v[224:239]
    v_mfma_f32_32x32x16_bf16 v[240:255], v[44:47], v[144:147], v[240:255]
    s_waitcnt vmcnt(12)
    s_barrier
    ds_read_b128 v[32:35], v9 offset:22528
    ds_read_b128 v[36:39], v9 offset:55296
    ds_read_b128 v[40:43], v10 offset:22528
    ds_read_b128 v[44:47], v10 offset:55296
    s_waitcnt lgkmcnt(4)
    v_mfma_f32_32x32x16_bf16 v[192:207], v[48:51], v[148:151], v[192:207]
    buffer_load_dwordx4 v8, s[8:11], s28 offen offset:2048 lds
    buffer_load_dwordx4 v[184:187], v8, s[8:11], s29 offen offset:2048
    v_mfma_f32_32x32x16_bf16 v[208:223], v[52:55], v[148:151], v[208:223]
    v_mfma_f32_32x32x16_bf16 v[224:239], v[56:59], v[148:151], v[224:239]
    v_mfma_f32_32x32x16_bf16 v[240:255], v[60:63], v[148:151], v[240:255]
    ds_read_b128 v[48:51], v9 offset:23552
    ds_read_b128 v[52:55], v9 offset:56320
    ds_read_b128 v[56:59], v10 offset:23552
    ds_read_b128 v[60:63], v10 offset:56320
    s_waitcnt lgkmcnt(4)
    v_mfma_f32_32x32x16_bf16 v[192:207], v[32:35], v[152:155], v[192:207]
    buffer_load_dwordx4 v8, s[8:11], s28 offen offset:3072 lds
    buffer_load_dwordx4 v[188:191], v8, s[8:11], s29 offen offset:3072
    s_add_u32 s28, s28, 4096
    s_add_u32 s29, s29, 4096
    v_mfma_f32_32x32x16_bf16 v[208:223], v[36:39], v[152:155], v[208:223]
    v_mfma_f32_32x32x16_bf16 v[224:239], v[40:43], v[152:155], v[224:239]
    v_mfma_f32_32x32x16_bf16 v[240:255], v[44:47], v[152:155], v[240:255]
    s_waitcnt vmcnt(12)
    s_barrier
    ds_read_b128 v[32:35], v9 offset:24576
    ds_read_b128 v[36:39], v9 offset:57344
    ds_read_b128 v[40:43], v10 offset:24576
    ds_read_b128 v[44:47], v10 offset:57344
    s_waitcnt lgkmcnt(4)
    v_mfma_f32_32x32x16_bf16 v[192:207], v[48:51], v[156:159], v[192:207]
    v_mfma_f32_32x32x16_bf16 v[208:223], v[52:55], v[156:159], v[208:223]
    v_mfma_f32_32x32x16_bf16 v[224:239], v[56:59], v[156:159], v[224:239]
    v_mfma_f32_32x32x16_bf16 v[240:255], v[60:63], v[156:159], v[240:255]
    ds_read_b128 v[48:51], v9 offset:25600
    ds_read_b128 v[52:55], v9 offset:58368
    ds_read_b128 v[56:59], v10 offset:25600
    ds_read_b128 v[60:63], v10 offset:58368
    s_waitcnt lgkmcnt(4)
    v_mfma_f32_32x32x16_bf16 v[192:207], v[32:35], v[160:163], v[192:207]
    v_mfma_f32_32x32x16_bf16 v[208:223], v[36:39], v[160:163], v[208:223]
    v_mfma_f32_32x32x16_bf16 v[224:239], v[40:43], v[160:163], v[224:239]
    v_mfma_f32_32x32x16_bf16 v[240:255], v[44:47], v[160:163], v[240:255]
    s_waitcnt vmcnt(8)
    s_barrier
    ds_read_b128 v[32:35], v9 offset:26624
    ds_read_b128 v[36:39], v9 offset:59392
    ds_read_b128 v[40:43], v10 offset:26624
    ds_read_b128 v[44:47], v10 offset:59392
    s_waitcnt lgkmcnt(4)
    v_mfma_f32_32x32x16_bf16 v[192:207], v[48:51], v[164:167], v[192:207]
    v_mfma_f32_32x32x16_bf16 v[208:223], v[52:55], v[164:167], v[208:223]
    v_mfma_f32_32x32x16_bf16 v[224:239], v[56:59], v[164:167], v[224:239]
    v_mfma_f32_32x32x16_bf16 v[240:255], v[60:63], v[164:167], v[240:255]
    ds_read_b128 v[48:51], v9 offset:27648
    ds_read_b128 v[52:55], v9 offset:60416
    ds_read_b128 v[56:59], v10 offset:27648
    ds_read_b128 v[60:63], v10 offset:60416
    s_waitcnt lgkmcnt(4)
    v_mfma_f32_32x32x16_bf16 v[192:207], v[32:35], v[168:171], v[192:207]
    v_mfma_f32_32x32x16_bf16 v[208:223], v[36:39], v[168:171], v[208:223]
    v_mfma_f32_32x32x16_bf16 v[224:239], v[40:43], v[168:171], v[224:239]
    v_mfma_f32_32x32x16_bf16 v[240:255], v[44:47], v[168:171], v[240:255]
    s_waitcnt vmcnt(4)
    s_barrier
    ds_read_b128 v[32:35], v9 offset:28672
    ds_read_b128 v[36:39], v9 offset:61440
    ds_read_b128 v[40:43], v10 offset:28672
    ds_read_b128 v[44:47], v10 offset:61440
    s_waitcnt lgkmcnt(4)
    v_mfma_f32_32x32x16_bf16 v[192:207], v[48:51], v[172:175], v[192:207]
    v_mfma_f32_32x32x16_bf16 v[208:223], v[52:55], v[172:175], v[208:223]
    v_mfma_f32_32x32x16_bf16 v[224:239], v[56:59], v[172:175], v[224:239]
    v_mfma_f32_32x32x16_bf16 v[240:255], v[60:63], v[172:175], v[240:255]
    ds_read_b128 v[48:51], v9 offset:29696
    ds_read_b128 v[52:55], v9 offset:62464
    ds_read_b128 v[56:59], v10 offset:29696
    ds_read_b128 v[60:63], v10 offset:62464
    s_waitcnt lgkmcnt(4)
    v_mfma_f32_32x32x16_bf16 v[192:207], v[32:35], v[176:179], v[192:207]
    v_mfma_f32_32x32x16_bf16 v[208:223], v[36:39], v[176:179], v[208:223]
    v_mfma_f32_32x32x16_bf16 v[224:239], v[40:43], v[176:179], v[224:239]
    v_mfma_f32_32x32x16_bf16 v[240:255], v[44:47], v[176:179], v[240:255]
    s_waitcnt vmcnt(0)
    s_barrier
    ds_read_b128 v[32:35], v9 offset:30720
    ds_read_b128 v[36:39], v9 offset:63488
    ds_read_b128 v[40:43], v10 offset:30720
    ds_read_b128 v[44:47], v10 offset:63488
    s_waitcnt lgkmcnt(4)
    v_mfma_f32_32x32x16_bf16 v[192:207], v[48:51], v[180:183], v[192:207]
    v_mfma_f32_32x32x16_bf16 v[208:223], v[52:55], v[180:183], v[208:223]
    v_mfma_f32_32x32x16_bf16 v[224:239], v[56:59], v[180:183], v[224:239]
    v_mfma_f32_32x32x16_bf16 v[240:255], v[60:63], v[180:183], v[240:255]
    ds_read_b128 v[48:51], v9 offset:31744
    ds_read_b128 v[52:55], v9 offset:64512
    ds_read_b128 v[56:59], v10 offset:31744
    ds_read_b128 v[60:63], v10 offset:64512
    s_waitcnt lgkmcnt(4)
    v_mfma_f32_32x32x16_bf16 v[192:207], v[32:35], v[184:187], v[192:207]
    v_mfma_f32_32x32x16_bf16 v[208:223], v[36:39], v[184:187], v[208:223]
    v_mfma_f32_32x32x16_bf16 v[224:239], v[40:43], v[184:187], v[224:239]
    v_mfma_f32_32x32x16_bf16 v[240:255], v[44:47], v[184:187], v[240:255]
    s_waitcnt lgkmcnt(0)
    v_mfma_f32_32x32x16_bf16 v[192:207], v[48:51], v[188:191], v[192:207]
    v_mfma_f32_32x32x16_bf16 v[208:223], v[52:55], v[188:191], v[208:223]
    v_mfma_f32_32x32x16_bf16 v[224:239], v[56:59], v[188:191], v[224:239]
    v_mfma_f32_32x32x16_bf16 v[240:255], v[60:63], v[188:191], v[240:255]
    s_cmp_eq_u32 s26, 0
    s_cbranch_scc1 K2SE_3
    s_nop 6
    v_cvt_pk_bf16_f32 v32, v192, v193
    v_cvt_pk_bf16_f32 v33, v194, v195
    v_cvt_pk_bf16_f32 v34, v196, v197
    v_cvt_pk_bf16_f32 v35, v198, v199
    s_add_u32 s19, s24, 0
    buffer_store_dwordx4 v[32:35], v8, s[8:11], s19 offen offset:0 sc1
    v_cvt_pk_bf16_f32 v36, v200, v201
    v_cvt_pk_bf16_f32 v37, v202, v203
    v_cvt_pk_bf16_f32 v38, v204, v205
    v_cvt_pk_bf16_f32 v39, v206, v207
    buffer_store_dwordx4 v[36:39], v8, s[8:11], s19 offen offset:1024 sc1
    v_cvt_pk_bf16_f32 v40, v208, v209
    v_cvt_pk_bf16_f32 v41, v210, v211
    v_cvt_pk_bf16_f32 v42, v212, v213
    v_cvt_pk_bf16_f32 v43, v214, v215
    buffer_store_dwordx4 v[40:43], v8, s[8:11], s19 offen offset:2048 sc1
    v_cvt_pk_bf16_f32 v44, v216, v217
    v_cvt_pk_bf16_f32 v45, v218, v219
    v_cvt_pk_bf16_f32 v46, v220, v221
    v_cvt_pk_bf16_f32 v47, v222, v223
    buffer_store_dwordx4 v[44:47], v8, s[8:11], s19 offen offset:3072 sc1
    v_cvt_pk_bf16_f32 v32, v224, v225
    v_cvt_pk_bf16_f32 v33, v226, v227
    v_cvt_pk_bf16_f32 v34, v228, v229
    v_cvt_pk_bf16_f32 v35, v230, v231
    s_add_u32 s19, s24, 4096
    buffer_store_dwordx4 v[32:35], v8, s[8:11], s19 offen offset:0 sc1
    v_cvt_pk_bf16_f32 v36, v232, v233
    v_cvt_pk_bf16_f32 v37, v234, v235
    v_cvt_pk_bf16_f32 v38, v236, v237
    v_cvt_pk_bf16_f32 v39, v238, v239
    buffer_store_dwordx4 v[36:39], v8, s[8:11], s19 offen offset:1024 sc1
    v_cvt_pk_bf16_f32 v40, v240, v241
    v_cvt_pk_bf16_f32 v41, v242, v243
    v_cvt_pk_bf16_f32 v42, v244, v245
    v_cvt_pk_bf16_f32 v43, v246, v247
    buffer_store_dwordx4 v[40:43], v8, s[8:11], s19 offen offset:2048 sc1
    v_cvt_pk_bf16_f32 v44, v248, v249
    v_cvt_pk_bf16_f32 v45, v250, v251
    v_cvt_pk_bf16_f32 v46, v252, v253
    v_cvt_pk_bf16_f32 v47, v254, v255
    buffer_store_dwordx4 v[44:47], v8, s[8:11], s19 offen offset:3072 sc1
    s_mov_b32 s36, s34
    s_mov_b32 s37, s35
    s_mov_b32 s38, 2048000
    s_mov_b32 s39, 131072
    s_lshl_b32 s19, s17, 3
    s_sub_u32 s20, s18, 16
    s_add_u32 s19, s19, s20
    s_lshl_b32 s19, s19, 2
    s_add_u32 s19, s19, s16
    s_lshl_b32 s19, s19, 13
    v_lshl_add_u32 v2, v0, 7, s19
    buffer_load_dword v3, v2, s[36:39], 0 offen
    s_endpgm
K2SE_3:
    s_nop 7
    s_nop 7
    s_cmp_lg_u32 s25, 7
    s_cbranch_scc1 K2NM_5
    v_mov_b32 v244, 0xff800000
    v_mov_b32 v245, 0xff800000
    v_mov_b32 v246, 0xff800000
    v_mov_b32 v247, 0xff800000
    v_mov_b32 v248, 0xff800000
    v_mov_b32 v249, 0xff800000
    v_mov_b32 v250, 0xff800000
    v_mov_b32 v251, 0xff800000
    v_mov_b32 v252, 0xff800000
    v_mov_b32 v253, 0xff800000
    v_mov_b32 v254, 0xff800000
    v_mov_b32 v255, 0xff800000
K2NM_5:
    v_max3_f32 v12, v192, v193, v194
    v_max3_f32 v13, v195, v196, v197
    v_max3_f32 v12, v12, v198, v199
    v_max3_f32 v13, v13, v200, v201
    v_max3_f32 v12, v12, v202, v203
    v_max3_f32 v13, v13, v204, v205
    v_max3_f32 v12, v12, v206, v207
    v_max3_f32 v13, v13, v208, v209
    v_max3_f32 v12, v12, v210, v211
    v_max3_f32 v13, v13, v212, v213
    v_max3_f32 v12, v12, v214, v215
    v_max3_f32 v13, v13, v216, v217
    v_max3_f32 v12, v12, v218, v219
    v_max3_f32 v13, v13, v220, v221
    v_max3_f32 v12, v12, v222, v223
    v_max3_f32 v13, v13, v224, v225
    v_max3_f32 v12, v12, v226, v227
    v_max3_f32 v13, v13, v228, v229
    v_max3_f32 v12, v12, v230, v231
    v_max3_f32 v13, v13, v232, v233
    v_max3_f32 v12, v12, v234, v235
    v_max3_f32 v13, v13, v236, v237
    v_max3_f32 v12, v12, v238, v239
    v_max3_f32 v13, v13, v240, v241
    v_max3_f32 v12, v12, v242, v243
    v_max3_f32 v13, v13, v244, v245
    v_max3_f32 v12, v12, v246, v247
    v_max3_f32 v13, v13, v248, v249
    v_max3_f32 v12, v12, v250, v251
    v_max3_f32 v13, v13, v252, v253
    v_max3_f32 v12, v12, v254, v255
    v_max_f32 v12, v12, v13
    v_mov_b32 v13, v12
    s_nop 1
    v_permlane32_swap_b32 v12, v13
    v_max_f32 v12, v12, v13
    s_mov_b32 s20, 0x3d8293ee
    v_mul_f32 v12, s20, v12
    v_mov_b32 v16, s20
    v_mov_b32 v17, s20
    v_sub_f32 v18, 0, v12
    v_sub_f32 v19, 0, v12
    v_mov_b32 v20, 0
    v_mov_b32 v21, 0
    v_mov_b32 v22, 0
    v_mov_b32 v23, 0
    v_pk_fma_f32 v[192:193], v[192:193], v[16:17], v[18:19]
    v_pk_fma_f32 v[194:195], v[194:195], v[16:17], v[18:19]
    v_pk_fma_f32 v[196:197], v[196:197], v[16:17], v[18:19]
    v_pk_fma_f32 v[198:199], v[198:199], v[16:17], v[18:19]
    v_exp_f32 v192, v192
    v_exp_f32 v193, v193
    v_exp_f32 v194, v194
    v_exp_f32 v195, v195
    v_exp_f32 v196, v196
    v_exp_f32 v197, v197
    v_exp_f32 v198, v198
    v_exp_f32 v199, v199
    v_cvt_pk_bf16_f32 v32, v192, v193
    v_cvt_pk_bf16_f32 v33, v194, v195
    v_cvt_pk_bf16_f32 v34, v196, v197
    v_cvt_pk_bf16_f32 v35, v198, v199
    s_add_u32 s19, s24, 0
    buffer_store_dwordx4 v[32:35], v8, s[8:11], s19 offen offset:0 sc1
    v_pk_add_f32 v[20:21], v[20:21], v[192:193]
    v_pk_add_f32 v[22:23], v[22:23], v[194:195]
    v_pk_add_f32 v[20:21], v[20:21], v[196:197]
    v_pk_add_f32 v[22:23], v[22:23], v[198:199]
    v_pk_fma_f32 v[200:201], v[200:201], v[16:17], v[18:19]
    v_pk_fma_f32 v[202:203], v[202:203], v[16:17], v[18:19]
    v_pk_fma_f32 v[204:205], v[204:205], v[16:17], v[18:19]
    v_pk_fma_f32 v[206:207], v[206:207], v[16:17], v[18:19]
    v_exp_f32 v200, v200
    v_exp_f32 v201, v201
    v_exp_f32 v202, v202
    v_exp_f32 v203, v203
    v_exp_f32 v204, v204
    v_exp_f32 v205, v205
    v_exp_f32 v206, v206
    v_exp_f32 v207, v207
    v_cvt_pk_bf16_f32 v36, v200, v201
    v_cvt_pk_bf16_f32 v37, v202, v203
    v_cvt_pk_bf16_f32 v38, v204, v205
    v_cvt_pk_bf16_f32 v39, v206, v207
    buffer_store_dwordx4 v[36:39], v8, s[8:11], s19 offen offset:1024 sc1
    v_pk_add_f32 v[20:21], v[20:21], v[200:201]
    v_pk_add_f32 v[22:23], v[22:23], v[202:203]
    v_pk_add_f32 v[20:21], v[20:21], v[204:205]
    v_pk_add_f32 v[22:23], v[22:23], v[206:207]
    v_pk_fma_f32 v[208:209], v[208:209], v[16:17], v[18:19]
    v_pk_fma_f32 v[210:211], v[210:211], v[16:17], v[18:19]
    v_pk_fma_f32 v[212:213], v[212:213], v[16:17], v[18:19]
    v_pk_fma_f32 v[214:215], v[214:215], v[16:17], v[18:19]
    v_exp_f32 v208, v208
    v_exp_f32 v209, v209
    v_exp_f32 v210, v210
    v_exp_f32 v211, v211
    v_exp_f32 v212, v212
    v_exp_f32 v213, v213
    v_exp_f32 v214, v214
    v_exp_f32 v215, v215
    v_cvt_pk_bf16_f32 v40, v208, v209
    v_cvt_pk_bf16_f32 v41, v210, v211
    v_cvt_pk_bf16_f32 v42, v212, v213
    v_cvt_pk_bf16_f32 v43, v214, v215
    buffer_store_dwordx4 v[40:43], v8, s[8:11], s19 offen offset:2048 sc1
    v_pk_add_f32 v[20:21], v[20:21], v[208:209]
    v_pk_add_f32 v[22:23], v[22:23], v[210:211]
    v_pk_add_f32 v[20:21], v[20:21], v[212:213]
    v_pk_add_f32 v[22:23], v[22:23], v[214:215]
    v_pk_fma_f32 v[216:217], v[216:217], v[16:17], v[18:19]
    v_pk_fma_f32 v[218:219], v[218:219], v[16:17], v[18:19]
    v_pk_fma_f32 v[220:221], v[220:221], v[16:17], v[18:19]
    v_pk_fma_f32 v[222:223], v[222:223], v[16:17], v[18:19]
    v_exp_f32 v216, v216
    v_exp_f32 v217, v217
    v_exp_f32 v218, v218
    v_exp_f32 v219, v219
    v_exp_f32 v220, v220
    v_exp_f32 v221, v221
    v_exp_f32 v222, v222
    v_exp_f32 v223, v223
    v_cvt_pk_bf16_f32 v44, v216, v217
    v_cvt_pk_bf16_f32 v45, v218, v219
    v_cvt_pk_bf16_f32 v46, v220, v221
    v_cvt_pk_bf16_f32 v47, v222, v223
    buffer_store_dwordx4 v[44:47], v8, s[8:11], s19 offen offset:3072 sc1
    v_pk_add_f32 v[20:21], v[20:21], v[216:217]
    v_pk_add_f32 v[22:23], v[22:23], v[218:219]
    v_pk_add_f32 v[20:21], v[20:21], v[220:221]
    v_pk_add_f32 v[22:23], v[22:23], v[222:223]
    v_pk_fma_f32 v[224:225], v[224:225], v[16:17], v[18:19]
    v_pk_fma_f32 v[226:227], v[226:227], v[16:17], v[18:19]
    v_pk_fma_f32 v[228:229], v[228:229], v[16:17], v[18:19]
    v_pk_fma_f32 v[230:231], v[230:231], v[16:17], v[18:19]
    v_exp_f32 v224, v224
    v_exp_f32 v225, v225
    v_exp_f32 v226, v226
    v_exp_f32 v227, v227
    v_exp_f32 v228, v228
    v_exp_f32 v229, v229
    v_exp_f32 v230, v230
    v_exp_f32 v231, v231
    v_cvt_pk_bf16_f32 v32, v224, v225
    v_cvt_pk_bf16_f32 v33, v226, v227
    v_cvt_pk_bf16_f32 v34, v228, v229
    v_cvt_pk_bf16_f32 v35, v230, v231
    s_add_u32 s19, s24, 4096
    buffer_store_dwordx4 v[32:35], v8, s[8:11], s19 offen offset:0 sc1
    v_pk_add_f32 v[20:21], v[20:21], v[224:225]
    v_pk_add_f32 v[22:23], v[22:23], v[226:227]
    v_pk_add_f32 v[20:21], v[20:21], v[228:229]
    v_pk_add_f32 v[22:23], v[22:23], v[230:231]
    v_pk_fma_f32 v[232:233], v[232:233], v[16:17], v[18:19]
    v_pk_fma_f32 v[234:235], v[234:235], v[16:17], v[18:19]
    v_pk_fma_f32 v[236:237], v[236:237], v[16:17], v[18:19]
    v_pk_fma_f32 v[238:239], v[238:239], v[16:17], v[18:19]
    v_exp_f32 v232, v232
    v_exp_f32 v233, v233
    v_exp_f32 v234, v234
    v_exp_f32 v235, v235
    v_exp_f32 v236, v236
    v_exp_f32 v237, v237
    v_exp_f32 v238, v238
    v_exp_f32 v239, v239
    v_cvt_pk_bf16_f32 v36, v232, v233
    v_cvt_pk_bf16_f32 v37, v234, v235
    v_cvt_pk_bf16_f32 v38, v236, v237
    v_cvt_pk_bf16_f32 v39, v238, v239
    buffer_store_dwordx4 v[36:39], v8, s[8:11], s19 offen offset:1024 sc1
    v_pk_add_f32 v[20:21], v[20:21], v[232:233]
    v_pk_add_f32 v[22:23], v[22:23], v[234:235]
    v_pk_add_f32 v[20:21], v[20:21], v[236:237]
    v_pk_add_f32 v[22:23], v[22:23], v[238:239]
    v_pk_fma_f32 v[240:241], v[240:241], v[16:17], v[18:19]
    v_pk_fma_f32 v[242:243], v[242:243], v[16:17], v[18:19]
    v_pk_fma_f32 v[244:245], v[244:245], v[16:17], v[18:19]
    v_pk_fma_f32 v[246:247], v[246:247], v[16:17], v[18:19]
    v_exp_f32 v240, v240
    v_exp_f32 v241, v241
    v_exp_f32 v242, v242
    v_exp_f32 v243, v243
    v_exp_f32 v244, v244
    v_exp_f32 v245, v245
    v_exp_f32 v246, v246
    v_exp_f32 v247, v247
    v_cvt_pk_bf16_f32 v40, v240, v241
    v_cvt_pk_bf16_f32 v41, v242, v243
    v_cvt_pk_bf16_f32 v42, v244, v245
    v_cvt_pk_bf16_f32 v43, v246, v247
    buffer_store_dwordx4 v[40:43], v8, s[8:11], s19 offen offset:2048 sc1
    v_pk_add_f32 v[20:21], v[20:21], v[240:241]
    v_pk_add_f32 v[22:23], v[22:23], v[242:243]
    v_pk_add_f32 v[20:21], v[20:21], v[244:245]
    v_pk_add_f32 v[22:23], v[22:23], v[246:247]
    v_pk_fma_f32 v[248:249], v[248:249], v[16:17], v[18:19]
    v_pk_fma_f32 v[250:251], v[250:251], v[16:17], v[18:19]
    v_pk_fma_f32 v[252:253], v[252:253], v[16:17], v[18:19]
    v_pk_fma_f32 v[254:255], v[254:255], v[16:17], v[18:19]
    v_exp_f32 v248, v248
    v_exp_f32 v249, v249
    v_exp_f32 v250, v250
    v_exp_f32 v251, v251
    v_exp_f32 v252, v252
    v_exp_f32 v253, v253
    v_exp_f32 v254, v254
    v_exp_f32 v255, v255
    v_cvt_pk_bf16_f32 v44, v248, v249
    v_cvt_pk_bf16_f32 v45, v250, v251
    v_cvt_pk_bf16_f32 v46, v252, v253
    v_cvt_pk_bf16_f32 v47, v254, v255
    buffer_store_dwordx4 v[44:47], v8, s[8:11], s19 offen offset:3072 sc1
    v_pk_add_f32 v[20:21], v[20:21], v[248:249]
    v_pk_add_f32 v[22:23], v[22:23], v[250:251]
    v_pk_add_f32 v[20:21], v[20:21], v[252:253]
    v_pk_add_f32 v[22:23], v[22:23], v[254:255]
    v_add_f32 v14, v20, v21
    v_add_f32 v13, v22, v23
    v_add_f32 v14, v14, v13
    v_mov_b32 v13, v14
    s_nop 1
    v_permlane32_swap_b32 v14, v13
    v_add_f32 v14, v14, v13
    v_cmp_gt_u32 vcc, 32, v0
    s_nop 1
    v_cndmask_b32 v14, v14, v12, vcc
    v_lshlrev_b32 v2, 2, v0
    buffer_store_dword v14, v2, s[8:11], s30 offen sc1
    s_endpgm
K2_CONV:
    s_sub_u32 s19, s18, 24
    s_lshl_b32 s25, s17, 1
    s_and_b32 s20, s19, 1
    s_add_u32 s25, s25, s20
    s_lshr_b32 s24, s19, 1
    s_lshl_b32 s26, s25, 7
    s_sub_u32 s26, s26, 16
    v_lshrrev_b32 v2, 4, v0
    v_and_b32 v3, 15, v0
    v_lshlrev_b32 v4, 2, v2
    v_xor_b32 v3, v3, v4
    v_lshlrev_b32 v3, 4, v3
    s_lshl_b32 s19, s24, 8
    v_add_u32 v3, s19, v3
    s_mul_i32 s19, s16, 20
    s_add_u32 s21, s19, s26
    v_add_u32 v4, s21, v2
    s_mul_i32 s20, s16, 5120
    s_waitcnt lgkmcnt(0)
    s_mov_b32 s8, s4
    s_mov_b32 s9, s5
    s_mov_b32 s10, 20643840
    s_mov_b32 s11, 131072
    v_min_u32 v5, 19, v0
    v_add_u32 v200, s19, v5
    v_add_u32 v202, s26, v200
    v_max_i32 v5, 0, v202
    v_min_i32 v5, 2047, v5
    v_lshlrev_b32 v5, 3, v5
    s_mov_b32 s27, 12910592
    buffer_load_dwordx2 v[160:161], v5, s[8:11], s27 offen
    s_mov_b32 s27, 12926976
    buffer_load_dwordx2 v[162:163], v5, s[8:11], s27 offen
    s_mov_b32 s27, 12943360
    buffer_load_dwordx2 v[164:165], v5, s[8:11], s27 offen
    s_mov_b32 s27, 12959744
    buffer_load_dwordx2 v[166:167], v5, s[8:11], s27 offen
    s_mov_b32 s27, 12976128
    buffer_load_dwordx2 v[168:169], v5, s[8:11], s27 offen
    s_mov_b32 s27, 12992512
    buffer_load_dwordx2 v[170:171], v5, s[8:11], s27 offen
    s_mov_b32 s27, 13008896
    buffer_load_dwordx2 v[172:173], v5, s[8:11], s27 offen
    s_mov_b32 s27, 13025280
    buffer_load_dwordx2 v[174:175], v5, s[8:11], s27 offen
    s_mov_b32 s27, 10813440
    v_add_u32 v5, 0, v4
    v_max_i32 v5, 0, v5
    v_min_i32 v5, 2047, v5
    v_lshl_add_u32 v5, v5, 10, v3
    s_add_u32 m0, s20, 0
    s_nop 0
    buffer_load_dwordx4 v5, s[8:11], s27 offen lds
    v_add_u32 v5, 4, v4
    v_max_i32 v5, 0, v5
    v_min_i32 v5, 2047, v5
    v_lshl_add_u32 v5, v5, 10, v3
    s_add_u32 m0, s20, 1024
    s_nop 0
    buffer_load_dwordx4 v5, s[8:11], s27 offen lds
    v_add_u32 v5, 8, v4
    v_max_i32 v5, 0, v5
    v_min_i32 v5, 2047, v5
    v_lshl_add_u32 v5, v5, 10, v3
    s_add_u32 m0, s20, 2048
    s_nop 0
    buffer_load_dwordx4 v5, s[8:11], s27 offen lds
    v_add_u32 v5, 12, v4
    v_max_i32 v5, 0, v5
    v_min_i32 v5, 2047, v5
    v_lshl_add_u32 v5, v5, 10, v3
    s_add_u32 m0, s20, 3072
    s_nop 0
    buffer_load_dwordx4 v5, s[8:11], s27 offen lds
    v_add_u32 v5, 16, v4
    v_max_i32 v5, 0, v5
    v_min_i32 v5, 2047, v5
    v_lshl_add_u32 v5, v5, 10, v3
    s_add_u32 m0, s20, 4096
    s_nop 0
    buffer_load_dwordx4 v5, s[8:11], s27 offen lds
    s_mov_b32 s12, s6
    s_mov_b32 s13, s7
    s_mov_b32 s14, 31744
    s_mov_b32 s15, 131072
    s_lshl_b32 s20, s16, 2
    v_add_u32 v5, s20, v2
    v_lshl_add_u32 v5, v5, 10, v3
    s_lshl_b32 s20, s16, 10
    s_add_u32 m0, s20, 40960
    s_nop 0
    buffer_load_dwordx4 v5, s[12:15], 0 offen lds
    s_lshr_b32 s28, s25, 3
    s_lshl_b32 s28, s28, 10
    s_mul_i32 s22, s16, 9760
    s_add_u32 s22, s22, 51200
    v_mov_b32 v192, 0
    v_mov_b32 v193, 0
    v_mov_b32 v194, 0
    v_mov_b32 v195, 0
    v_lshlrev_b32 v2, 4, v0
    v_add_u32 v2, s22, v2
    ds_write_b128 v2, v[192:195] offset:5664
    ds_write_b128 v2, v[192:195] offset:6688
    ds_write_b128 v2, v[192:195] offset:7712
    ds_write_b128 v2, v[192:195] offset:8736
    v_bfe_u32 v2, v0, 2, 2
    v_lshrrev_b32 v4, 4, v0
    v_bfe_u32 v5, v0, 1, 1
    s_lshl_b32 s19, s16, 1
    v_or_b32 v5, s19, v5
    v_lshlrev_b32 v6, 2, v2
    v_xor_b32 v5, v5, v6
    v_lshlrev_b32 v5, 4, v5
    v_lshl_add_u32 v5, v2, 8, v5
    v_lshl_add_u32 v5, v4, 10, v5
    v_and_b32 v6, 1, v0
    v_lshl_add_u32 v8, v6, 3, v5
    v_lshlrev_b32 v9, 5, v4
    v_and_b32 v2, 15, v0
    v_mul_u32_u24 v5, 352, v2
    v_lshl_add_u32 v5, v4, 3, v5
    v_lshrrev_b32 v6, 3, v2
    v_lshl_add_u32 v5, v6, 3, v5
    v_add_u32 v10, s22, v5
    v_mul_u32_u24 v5, 200, v2
    v_lshl_add_u32 v5, v4, 3, v5
    v_add_u32 v3, s22, v5
    v_lshrrev_b32 v2, 2, v0
    v_and_b32 v4, 3, v0
    v_mul_u32_u24 v5, 352, v2
    v_lshl_add_u32 v5, v4, 3, v5
    v_lshrrev_b32 v6, 3, v2
    v_lshl_add_u32 v5, v6, 3, v5
    v_add_u32 v11, s22, v5
    v_mul_u32_u24 v5, 200, v2
    v_lshlrev_b32 v6, 1, v4
    v_sub_u32 v5, v5, v6
    v_and_b32 v6, 1, v4
    v_mul_u32_u24 v6, 94, v6
    v_sub_u32 v5, v5, v6
    v_add_u32 v5, 108, v5
    v_add_u32 v12, s22, v5
    v_lshlrev_b32 v13, 4, v0
    s_lshl_b32 s19, s25, 2
    s_mul_i32 s19, s19, 33792
    s_lshl_b32 s20, s24, 3
    s_add_u32 s20, s20, s16
    s_lshl_b32 s20, s20, 10
    s_add_u32 s29, s19, s20
    s_waitcnt vmcnt(6)
    s_mov_b32 s19, 0x3b000000
    s_mov_b32 s20, 0x3727c5ac
    v_add_f32 v160, v160, v168
    v_add_f32 v161, v161, v169
    v_add_f32 v162, v162, v170
    v_add_f32 v163, v163, v171
    v_add_f32 v164, v164, v172
    v_add_f32 v165, v165, v173
    v_add_f32 v166, v166, v174
    v_add_f32 v167, v167, v175
    v_add_f32 v160, v160, v164
    v_add_f32 v161, v161, v165
    v_add_f32 v162, v162, v166
    v_add_f32 v163, v163, v167
    v_add_f32 v160, v160, v162
    v_add_f32 v161, v161, v163
    v_mul_f32 v160, s19, v160
    v_mul_f32 v161, s19, v161
    v_fma_f32 v161, -v160, v160, v161
    v_max_f32 v161, 0, v161
    v_add_f32 v161, s20, v161
    v_rsq_f32 v162, v161
    s_nop 0
    v_mul_f32 v163, v160, v162
    v_sub_f32 v163, 0, v163
    v_subrev_u32 v2, s28, v202
    v_cmp_gt_u32 vcc, 1000, v2
    s_nop 1
    v_cndmask_b32 v162, 0, v162, vcc
    v_cndmask_b32 v163, 0, v163, vcc
    v_lshlrev_b32 v2, 3, v200
    ds_write_b64 v2, v[162:163] offset:49152
    s_waitcnt vmcnt(0) lgkmcnt(0)
    s_barrier
    s_add_u32 s19, s29, 6488064
    buffer_load_dwordx4 v[144:147], v13, s[8:11], s19 offen
    s_add_u32 s19, s19, 33792
    buffer_load_dwordx4 v[148:151], v13, s[8:11], s19 offen
    s_add_u32 s19, s19, 33792
    buffer_load_dwordx4 v[152:155], v13, s[8:11], s19 offen
    s_add_u32 s19, s19, 33792
    buffer_load_dwordx4 v[156:159], v13, s[8:11], s19 offen
    ds_read_b64_tr_b16 v[204:205], v8 offset:40960
    ds_read_b64_tr_b16 v[206:207], v8 offset:45056
    ds_read_b64_tr_b16 v[160:161], v8 offset:0
    ds_read_b128 v[16:19], v9 offset:49152
    ds_read_b128 v[20:23], v9 offset:49168
    ds_read_b64_tr_b16 v[162:163], v8 offset:4096
    ds_read_b128 v[24:27], v9 offset:49280
    ds_read_b128 v[28:31], v9 offset:49296
    ds_read_b64_tr_b16 v[164:165], v8 offset:8192
    ds_read_b128 v[32:35], v9 offset:49408
    ds_read_b128 v[36:39], v9 offset:49424
    ds_read_b64_tr_b16 v[166:167], v8 offset:12288
    ds_read_b128 v[40:43], v9 offset:49536
    ds_read_b128 v[44:47], v9 offset:49552
    ds_read_b64_tr_b16 v[168:169], v8 offset:16384
    ds_read_b128 v[48:51], v9 offset:49664
    ds_read_b128 v[52:55], v9 offset:49680
    ds_read_b64_tr_b16 v[170:171], v8 offset:20480
    ds_read_b128 v[56:59], v9 offset:49792
    ds_read_b128 v[60:63], v9 offset:49808
    ds_read_b64_tr_b16 v[172:173], v8 offset:24576
    ds_read_b128 v[64:67], v9 offset:49920
    ds_read_b128 v[68:71], v9 offset:49936
    ds_read_b64_tr_b16 v[174:175], v8 offset:28672
    ds_read_b128 v[72:75], v9 offset:50048
    ds_read_b128 v[76:79], v9 offset:50064
    ds_read_b64_tr_b16 v[176:177], v8 offset:32768
    ds_read_b128 v[80:83], v9 offset:50176
    ds_read_b128 v[84:87], v9 offset:50192
    ds_read_b64_tr_b16 v[178:179], v8 offset:36864
    ds_read_b128 v[88:91], v9 offset:50304
    ds_read_b128 v[92:95], v9 offset:50320
    s_waitcnt lgkmcnt(15)
    ds_write_b64 v3, v[204:205] offset:5680
    ds_write_b16 v3, v204 offset:5774
    ds_write_b16_d16_hi v3, v204 offset:5776
    ds_write_b16 v3, v205 offset:5778
    ds_write_b16_d16_hi v3, v205 offset:5780
    ds_write_b64 v3, v[206:207] offset:5712
    ds_write_b16 v3, v206 offset:5806
    ds_write_b16_d16_hi v3, v206 offset:5808
    ds_write_b16 v3, v207 offset:5810
    ds_write_b16_d16_hi v3, v207 offset:5812
    s_waitcnt lgkmcnt(10)
    v_lshlrev_b32 v184, 16, v160
    v_and_b32 v185, 0xffff0000, v160
    v_lshlrev_b32 v186, 16, v161
    v_and_b32 v187, 0xffff0000, v161
    v_fma_f32 v184, v184, v16, v17
    v_fma_f32 v185, v185, v18, v19
    v_fma_f32 v186, v186, v20, v21
    v_fma_f32 v187, v187, v22, v23
    v_cvt_pk_bf16_f32 v160, v184, v185
    v_cvt_pk_bf16_f32 v161, v186, v187
    ds_write_b64 v10, v[160:161] offset:0
    v_lshlrev_b32 v188, 16, v162
    v_and_b32 v189, 0xffff0000, v162
    v_lshlrev_b32 v190, 16, v163
    v_and_b32 v191, 0xffff0000, v163
    v_fma_f32 v188, v188, v24, v25
    v_fma_f32 v189, v189, v26, v27
    v_fma_f32 v190, v190, v28, v29
    v_fma_f32 v191, v191, v30, v31
    v_cvt_pk_bf16_f32 v162, v188, v189
    v_cvt_pk_bf16_f32 v163, v190, v191
    ds_write_b64 v10, v[162:163] offset:32
    v_lshlrev_b32 v184, 16, v164
    v_and_b32 v185, 0xffff0000, v164
    v_lshlrev_b32 v186, 16, v165
    v_and_b32 v187, 0xffff0000, v165
    v_fma_f32 v184, v184, v32, v33
    v_fma_f32 v185, v185, v34, v35
    v_fma_f32 v186, v186, v36, v37
    v_fma_f32 v187, v187, v38, v39
    v_cvt_pk_bf16_f32 v164, v184, v185
    v_cvt_pk_bf16_f32 v165, v186, v187
    ds_write_b64 v10, v[164:165] offset:64
    v_lshlrev_b32 v188, 16, v166
    v_and_b32 v189, 0xffff0000, v166
    v_lshlrev_b32 v190, 16, v167
    v_and_b32 v191, 0xffff0000, v167
    v_fma_f32 v188, v188, v40, v41
    v_fma_f32 v189, v189, v42, v43
    v_fma_f32 v190, v190, v44, v45
    v_fma_f32 v191, v191, v46, v47
    v_cvt_pk_bf16_f32 v166, v188, v189
    v_cvt_pk_bf16_f32 v167, v190, v191
    ds_write_b64 v10, v[166:167] offset:96
    v_lshlrev_b32 v184, 16, v168
    v_and_b32 v185, 0xffff0000, v168
    v_lshlrev_b32 v186, 16, v169
    v_and_b32 v187, 0xffff0000, v169
    v_fma_f32 v184, v184, v48, v49
    v_fma_f32 v185, v185, v50, v51
    v_fma_f32 v186, v186, v52, v53
    v_fma_f32 v187, v187, v54, v55
    v_cvt_pk_bf16_f32 v168, v184, v185
    v_cvt_pk_bf16_f32 v169, v186, v187
    ds_write_b64 v10, v[168:169] offset:128
    v_lshlrev_b32 v188, 16, v170
    v_and_b32 v189, 0xffff0000, v170
    v_lshlrev_b32 v190, 16, v171
    v_and_b32 v191, 0xffff0000, v171
    v_fma_f32 v188, v188, v56, v57
    v_fma_f32 v189, v189, v58, v59
    v_fma_f32 v190, v190, v60, v61
    v_fma_f32 v191, v191, v62, v63
    v_cvt_pk_bf16_f32 v170, v188, v189
    v_cvt_pk_bf16_f32 v171, v190, v191
    ds_write_b64 v10, v[170:171] offset:160
    v_lshlrev_b32 v184, 16, v172
    v_and_b32 v185, 0xffff0000, v172
    v_lshlrev_b32 v186, 16, v173
    v_and_b32 v187, 0xffff0000, v173
    v_fma_f32 v184, v184, v64, v65
    v_fma_f32 v185, v185, v66, v67
    v_fma_f32 v186, v186, v68, v69
    v_fma_f32 v187, v187, v70, v71
    v_cvt_pk_bf16_f32 v172, v184, v185
    v_cvt_pk_bf16_f32 v173, v186, v187
    ds_write_b64 v10, v[172:173] offset:192
    v_lshlrev_b32 v188, 16, v174
    v_and_b32 v189, 0xffff0000, v174
    v_lshlrev_b32 v190, 16, v175
    v_and_b32 v191, 0xffff0000, v175
    v_fma_f32 v188, v188, v72, v73
    v_fma_f32 v189, v189, v74, v75
    v_fma_f32 v190, v190, v76, v77
    v_fma_f32 v191, v191, v78, v79
    v_cvt_pk_bf16_f32 v174, v188, v189
    v_cvt_pk_bf16_f32 v175, v190, v191
    ds_write_b64 v10, v[174:175] offset:224
    v_lshlrev_b32 v184, 16, v176
    v_and_b32 v185, 0xffff0000, v176
    v_lshlrev_b32 v186, 16, v177
    v_and_b32 v187, 0xffff0000, v177
    v_fma_f32 v184, v184, v80, v81
    v_fma_f32 v185, v185, v82, v83
    v_fma_f32 v186, v186, v84, v85
    v_fma_f32 v187, v187, v86, v87
    v_cvt_pk_bf16_f32 v176, v184, v185
    v_cvt_pk_bf16_f32 v177, v186, v187
    ds_write_b64 v10, v[176:177] offset:256
    v_lshlrev_b32 v188, 16, v178
    v_and_b32 v189, 0xffff0000, v178
    v_lshlrev_b32 v190, 16, v179
    v_and_b32 v191, 0xffff0000, v179
    v_fma_f32 v188, v188, v88, v89
    v_fma_f32 v189, v189, v90, v91
    v_fma_f32 v190, v190, v92, v93
    v_fma_f32 v191, v191, v94, v95
    v_cvt_pk_bf16_f32 v178, v188, v189
    v_cvt_pk_bf16_f32 v179, v190, v191
    ds_write_b64 v10, v[178:179] offset:288
    s_waitcnt lgkmcnt(0)
    v_add_u32 v12, 5664, v12
    ds_read2_b32 v[92:93], v12 offset0:0 offset1:1
    ds_read2_b32 v[94:95], v12 offset0:2 offset1:3
    ds_read2_b32 v[96:97], v12 offset0:4 offset1:5
    ds_read2_b32 v[98:99], v12 offset0:6 offset1:7
    ds_read2_b32 v[100:101], v12 offset0:8 offset1:9
    ds_read2_b32 v[102:103], v12 offset0:10 offset1:11
    ds_read2_b32 v[104:105], v12 offset0:12 offset1:13
    ds_read2_b32 v[106:107], v12 offset0:14 offset1:15
    ds_read2_b32 v[108:109], v12 offset0:16 offset1:17
    ds_read_b64 v[16:17], v11 offset:0
    ds_read_b64 v[18:19], v11 offset:8
    ds_read_b64 v[20:21], v11 offset:16
    ds_read_b64 v[22:23], v11 offset:24
    ds_read_b64 v[24:25], v11 offset:32
    ds_read_b64 v[26:27], v11 offset:40
    ds_read_b64 v[28:29], v11 offset:48
    ds_read_b64 v[30:31], v11 offset:56
    ds_read_b64 v[32:33], v11 offset:64
    ds_read_b64 v[34:35], v11 offset:72
    ds_read_b64 v[36:37], v11 offset:80
    ds_read_b64 v[38:39], v11 offset:88
    ds_read_b64 v[40:41], v11 offset:96
    ds_read_b64 v[42:43], v11 offset:104
    ds_read_b64 v[44:45], v11 offset:112
    ds_read_b64 v[46:47], v11 offset:120
    ds_read_b64 v[48:49], v11 offset:128
    ds_read_b64 v[50:51], v11 offset:136
    ds_read_b64 v[52:53], v11 offset:144
    ds_read_b64 v[54:55], v11 offset:152
    ds_read_b64 v[56:57], v11 offset:160
    ds_read_b64 v[58:59], v11 offset:168
    ds_read_b64 v[60:61], v11 offset:176
    ds_read_b64 v[62:63], v11 offset:184
    ds_read_b64 v[64:65], v11 offset:192
    ds_read_b64 v[66:67], v11 offset:200
    ds_read_b64 v[68:69], v11 offset:208
    ds_read_b64 v[70:71], v11 offset:216
    ds_read_b64 v[72:73], v11 offset:224
    ds_read_b64 v[74:75], v11 offset:232
    ds_read_b64 v[76:77], v11 offset:240
    ds_read_b64 v[78:79], v11 offset:248
    ds_read_b64 v[80:81], v11 offset:256
    ds_read_b64 v[82:83], v11 offset:264
    ds_read_b64 v[84:85], v11 offset:272
    ds_read_b64 v[86:87], v11 offset:280
    ds_read_b64 v[88:89], v11 offset:288
    s_waitcnt lgkmcnt(0)
    v_mfma_f32_4x4x4_16b_bf16 v[112:115], v[92:93], v[16:17], 0
    v_mfma_f32_4x4x4_16b_bf16 v[116:119], v[92:93], v[24:25], 0
    v_mfma_f32_4x4x4_16b_bf16 v[120:123], v[92:93], v[32:33], 0
    v_mfma_f32_4x4x4_16b_bf16 v[124:127], v[92:93], v[40:41], 0
    v_mfma_f32_4x4x4_16b_bf16 v[128:131], v[92:93], v[48:49], 0
    v_mfma_f32_4x4x4_16b_bf16 v[132:135], v[92:93], v[56:57], 0
    v_mfma_f32_4x4x4_16b_bf16 v[136:139], v[92:93], v[64:65], 0
    v_mfma_f32_4x4x4_16b_bf16 v[140:143], v[92:93], v[72:73], 0
    v_mfma_f32_4x4x4_16b_bf16 v[112:115], v[94:95], v[18:19], v[112:115]
    v_mfma_f32_4x4x4_16b_bf16 v[116:119], v[94:95], v[26:27], v[116:119]
    v_mfma_f32_4x4x4_16b_bf16 v[120:123], v[94:95], v[34:35], v[120:123]
    v_mfma_f32_4x4x4_16b_bf16 v[124:127], v[94:95], v[42:43], v[124:127]
    v_mfma_f32_4x4x4_16b_bf16 v[128:131], v[94:95], v[50:51], v[128:131]
    v_mfma_f32_4x4x4_16b_bf16 v[132:135], v[94:95], v[58:59], v[132:135]
    v_mfma_f32_4x4x4_16b_bf16 v[136:139], v[94:95], v[66:67], v[136:139]
    v_mfma_f32_4x4x4_16b_bf16 v[140:143], v[94:95], v[74:75], v[140:143]
    v_mfma_f32_4x4x4_16b_bf16 v[112:115], v[96:97], v[20:21], v[112:115]
    v_mfma_f32_4x4x4_16b_bf16 v[116:119], v[96:97], v[28:29], v[116:119]
    v_mfma_f32_4x4x4_16b_bf16 v[120:123], v[96:97], v[36:37], v[120:123]
    v_mfma_f32_4x4x4_16b_bf16 v[124:127], v[96:97], v[44:45], v[124:127]
    v_mfma_f32_4x4x4_16b_bf16 v[128:131], v[96:97], v[52:53], v[128:131]
    v_mfma_f32_4x4x4_16b_bf16 v[132:135], v[96:97], v[60:61], v[132:135]
    v_mfma_f32_4x4x4_16b_bf16 v[136:139], v[96:97], v[68:69], v[136:139]
    v_mfma_f32_4x4x4_16b_bf16 v[140:143], v[96:97], v[76:77], v[140:143]
    v_mfma_f32_4x4x4_16b_bf16 v[112:115], v[98:99], v[22:23], v[112:115]
    v_mfma_f32_4x4x4_16b_bf16 v[116:119], v[98:99], v[30:31], v[116:119]
    v_mfma_f32_4x4x4_16b_bf16 v[120:123], v[98:99], v[38:39], v[120:123]
    v_mfma_f32_4x4x4_16b_bf16 v[124:127], v[98:99], v[46:47], v[124:127]
    v_mfma_f32_4x4x4_16b_bf16 v[128:131], v[98:99], v[54:55], v[128:131]
    v_mfma_f32_4x4x4_16b_bf16 v[132:135], v[98:99], v[62:63], v[132:135]
    v_mfma_f32_4x4x4_16b_bf16 v[136:139], v[98:99], v[70:71], v[136:139]
    v_mfma_f32_4x4x4_16b_bf16 v[140:143], v[98:99], v[78:79], v[140:143]
    v_mfma_f32_4x4x4_16b_bf16 v[112:115], v[100:101], v[24:25], v[112:115]
    v_mfma_f32_4x4x4_16b_bf16 v[116:119], v[100:101], v[32:33], v[116:119]
    v_mfma_f32_4x4x4_16b_bf16 v[120:123], v[100:101], v[40:41], v[120:123]
    v_mfma_f32_4x4x4_16b_bf16 v[124:127], v[100:101], v[48:49], v[124:127]
    v_mfma_f32_4x4x4_16b_bf16 v[128:131], v[100:101], v[56:57], v[128:131]
    v_mfma_f32_4x4x4_16b_bf16 v[132:135], v[100:101], v[64:65], v[132:135]
    v_mfma_f32_4x4x4_16b_bf16 v[136:139], v[100:101], v[72:73], v[136:139]
    v_mfma_f32_4x4x4_16b_bf16 v[140:143], v[100:101], v[80:81], v[140:143]
    v_mfma_f32_4x4x4_16b_bf16 v[112:115], v[102:103], v[26:27], v[112:115]
    v_mfma_f32_4x4x4_16b_bf16 v[116:119], v[102:103], v[34:35], v[116:119]
    v_mfma_f32_4x4x4_16b_bf16 v[120:123], v[102:103], v[42:43], v[120:123]
    v_mfma_f32_4x4x4_16b_bf16 v[124:127], v[102:103], v[50:51], v[124:127]
    v_mfma_f32_4x4x4_16b_bf16 v[128:131], v[102:103], v[58:59], v[128:131]
    v_mfma_f32_4x4x4_16b_bf16 v[132:135], v[102:103], v[66:67], v[132:135]
    v_mfma_f32_4x4x4_16b_bf16 v[136:139], v[102:103], v[74:75], v[136:139]
    v_mfma_f32_4x4x4_16b_bf16 v[140:143], v[102:103], v[82:83], v[140:143]
    v_mfma_f32_4x4x4_16b_bf16 v[112:115], v[104:105], v[28:29], v[112:115]
    v_mfma_f32_4x4x4_16b_bf16 v[116:119], v[104:105], v[36:37], v[116:119]
    v_mfma_f32_4x4x4_16b_bf16 v[120:123], v[104:105], v[44:45], v[120:123]
    v_mfma_f32_4x4x4_16b_bf16 v[124:127], v[104:105], v[52:53], v[124:127]
    v_mfma_f32_4x4x4_16b_bf16 v[128:131], v[104:105], v[60:61], v[128:131]
    v_mfma_f32_4x4x4_16b_bf16 v[132:135], v[104:105], v[68:69], v[132:135]
    v_mfma_f32_4x4x4_16b_bf16 v[136:139], v[104:105], v[76:77], v[136:139]
    v_mfma_f32_4x4x4_16b_bf16 v[140:143], v[104:105], v[84:85], v[140:143]
    v_mfma_f32_4x4x4_16b_bf16 v[112:115], v[106:107], v[30:31], v[112:115]
    v_mfma_f32_4x4x4_16b_bf16 v[116:119], v[106:107], v[38:39], v[116:119]
    v_mfma_f32_4x4x4_16b_bf16 v[120:123], v[106:107], v[46:47], v[120:123]
    v_mfma_f32_4x4x4_16b_bf16 v[124:127], v[106:107], v[54:55], v[124:127]
    v_mfma_f32_4x4x4_16b_bf16 v[128:131], v[106:107], v[62:63], v[128:131]
    v_mfma_f32_4x4x4_16b_bf16 v[132:135], v[106:107], v[70:71], v[132:135]
    v_mfma_f32_4x4x4_16b_bf16 v[136:139], v[106:107], v[78:79], v[136:139]
    v_mfma_f32_4x4x4_16b_bf16 v[140:143], v[106:107], v[86:87], v[140:143]
    v_mfma_f32_4x4x4_16b_bf16 v[112:115], v[108:109], v[32:33], v[112:115]
    v_mfma_f32_4x4x4_16b_bf16 v[116:119], v[108:109], v[40:41], v[116:119]
    v_mfma_f32_4x4x4_16b_bf16 v[120:123], v[108:109], v[48:49], v[120:123]
    v_mfma_f32_4x4x4_16b_bf16 v[124:127], v[108:109], v[56:57], v[124:127]
    v_mfma_f32_4x4x4_16b_bf16 v[128:131], v[108:109], v[64:65], v[128:131]
    v_mfma_f32_4x4x4_16b_bf16 v[132:135], v[108:109], v[72:73], v[132:135]
    v_mfma_f32_4x4x4_16b_bf16 v[136:139], v[108:109], v[80:81], v[136:139]
    v_mfma_f32_4x4x4_16b_bf16 v[140:143], v[108:109], v[88:89], v[140:143]
    v_lshrrev_b32 v2, 2, v0
    v_and_b32 v4, 3, v0
    v_mul_u32_u24 v5, 288, v2
    v_lshl_add_u32 v5, v4, 3, v5
    v_add_u32 v5, s22, v5
    v_cvt_pk_bf16_f32 v16, v112, v113
    v_cvt_pk_bf16_f32 v17, v114, v115
    ds_write_b64 v5, v[16:17] offset:0
    v_cvt_pk_bf16_f32 v18, v116, v117
    v_cvt_pk_bf16_f32 v19, v118, v119
    ds_write_b64 v5, v[18:19] offset:32
    v_cvt_pk_bf16_f32 v20, v120, v121
    v_cvt_pk_bf16_f32 v21, v122, v123
    ds_write_b64 v5, v[20:21] offset:64
    v_cvt_pk_bf16_f32 v22, v124, v125
    v_cvt_pk_bf16_f32 v23, v126, v127
    ds_write_b64 v5, v[22:23] offset:96
    v_cvt_pk_bf16_f32 v24, v128, v129
    v_cvt_pk_bf16_f32 v25, v130, v131
    ds_write_b64 v5, v[24:25] offset:128
    v_cvt_pk_bf16_f32 v26, v132, v133
    v_cvt_pk_bf16_f32 v27, v134, v135
    ds_write_b64 v5, v[26:27] offset:160
    v_cvt_pk_bf16_f32 v28, v136, v137
    v_cvt_pk_bf16_f32 v29, v138, v139
    ds_write_b64 v5, v[28:29] offset:192
    v_cvt_pk_bf16_f32 v30, v140, v141
    v_cvt_pk_bf16_f32 v31, v142, v143
    ds_write_b64 v5, v[30:31] offset:224
    v_lshrrev_b32 v2, 5, v0
    v_bfe_u32 v3, v0, 2, 2
    v_lshl_add_u32 v2, v2, 3, v3
    v_mul_u32_u24 v2, 288, v2
    v_bfe_u32 v3, v0, 4, 1
    v_lshl_add_u32 v2, v3, 5, v2
    v_and_b32 v3, 3, v0
    v_lshl_add_u32 v2, v3, 3, v2
    v_add_u32 v4, s22, v2
    s_waitcnt lgkmcnt(0)
    ds_read_b64_tr_b16 v[32:33], v4 offset:0
    ds_read_b64_tr_b16 v[34:35], v4 offset:1152
    ds_read_b64_tr_b16 v[36:37], v4 offset:64
    ds_read_b64_tr_b16 v[38:39], v4 offset:1216
    ds_read_b64_tr_b16 v[40:41], v4 offset:128
    ds_read_b64_tr_b16 v[42:43], v4 offset:1280
    ds_read_b64_tr_b16 v[44:45], v4 offset:192
    ds_read_b64_tr_b16 v[46:47], v4 offset:1344
    s_waitcnt vmcnt(0)
    s_add_u32 s19, s29, 8650752
    s_waitcnt lgkmcnt(6)
    v_lshlrev_b32 v112, 16, v144
    v_and_b32 v113, 0xffff0000, v144
    v_lshlrev_b32 v114, 16, v32
    v_and_b32 v115, 0xffff0000, v32
    v_lshlrev_b32 v116, 16, v145
    v_and_b32 v117, 0xffff0000, v145
    v_lshlrev_b32 v118, 16, v33
    v_and_b32 v119, 0xffff0000, v33
    v_lshlrev_b32 v120, 16, v146
    v_and_b32 v121, 0xffff0000, v146
    v_lshlrev_b32 v122, 16, v34
    v_and_b32 v123, 0xffff0000, v34
    v_lshlrev_b32 v124, 16, v147
    v_and_b32 v125, 0xffff0000, v147
    v_lshlrev_b32 v126, 16, v35
    v_and_b32 v127, 0xffff0000, v35
    v_mul_f32 v112, v112, v114
    v_mul_f32 v113, v113, v115
    v_mul_f32 v116, v116, v118
    v_mul_f32 v117, v117, v119
    v_mul_f32 v120, v120, v122
    v_mul_f32 v121, v121, v123
    v_mul_f32 v124, v124, v126
    v_mul_f32 v125, v125, v127
    v_cvt_pk_bf16_f32 v144, v112, v113
    v_cvt_pk_bf16_f32 v145, v116, v117
    v_cvt_pk_bf16_f32 v146, v120, v121
    v_cvt_pk_bf16_f32 v147, v124, v125
    buffer_store_dwordx4 v[144:147], v13, s[8:11], s19 offen sc1
    s_add_u32 s19, s19, 33792
    s_waitcnt lgkmcnt(4)
    v_lshlrev_b32 v112, 16, v148
    v_and_b32 v113, 0xffff0000, v148
    v_lshlrev_b32 v114, 16, v36
    v_and_b32 v115, 0xffff0000, v36
    v_lshlrev_b32 v116, 16, v149
    v_and_b32 v117, 0xffff0000, v149
    v_lshlrev_b32 v118, 16, v37
    v_and_b32 v119, 0xffff0000, v37
    v_lshlrev_b32 v120, 16, v150
    v_and_b32 v121, 0xffff0000, v150
    v_lshlrev_b32 v122, 16, v38
    v_and_b32 v123, 0xffff0000, v38
    v_lshlrev_b32 v124, 16, v151
    v_and_b32 v125, 0xffff0000, v151
    v_lshlrev_b32 v126, 16, v39
    v_and_b32 v127, 0xffff0000, v39
    v_mul_f32 v112, v112, v114
    v_mul_f32 v113, v113, v115
    v_mul_f32 v116, v116, v118
    v_mul_f32 v117, v117, v119
    v_mul_f32 v120, v120, v122
    v_mul_f32 v121, v121, v123
    v_mul_f32 v124, v124, v126
    v_mul_f32 v125, v125, v127
    v_cvt_pk_bf16_f32 v148, v112, v113
    v_cvt_pk_bf16_f32 v149, v116, v117
    v_cvt_pk_bf16_f32 v150, v120, v121
    v_cvt_pk_bf16_f32 v151, v124, v125
    buffer_store_dwordx4 v[148:151], v13, s[8:11], s19 offen sc1
    s_add_u32 s19, s19, 33792
    s_waitcnt lgkmcnt(2)
    v_lshlrev_b32 v112, 16, v152
    v_and_b32 v113, 0xffff0000, v152
    v_lshlrev_b32 v114, 16, v40
    v_and_b32 v115, 0xffff0000, v40
    v_lshlrev_b32 v116, 16, v153
    v_and_b32 v117, 0xffff0000, v153
    v_lshlrev_b32 v118, 16, v41
    v_and_b32 v119, 0xffff0000, v41
    v_lshlrev_b32 v120, 16, v154
    v_and_b32 v121, 0xffff0000, v154
    v_lshlrev_b32 v122, 16, v42
    v_and_b32 v123, 0xffff0000, v42
    v_lshlrev_b32 v124, 16, v155
    v_and_b32 v125, 0xffff0000, v155
    v_lshlrev_b32 v126, 16, v43
    v_and_b32 v127, 0xffff0000, v43
    v_mul_f32 v112, v112, v114
    v_mul_f32 v113, v113, v115
    v_mul_f32 v116, v116, v118
    v_mul_f32 v117, v117, v119
    v_mul_f32 v120, v120, v122
    v_mul_f32 v121, v121, v123
    v_mul_f32 v124, v124, v126
    v_mul_f32 v125, v125, v127
    v_cvt_pk_bf16_f32 v152, v112, v113
    v_cvt_pk_bf16_f32 v153, v116, v117
    v_cvt_pk_bf16_f32 v154, v120, v121
    v_cvt_pk_bf16_f32 v155, v124, v125
    buffer_store_dwordx4 v[152:155], v13, s[8:11], s19 offen sc1
    s_add_u32 s19, s19, 33792
    s_waitcnt lgkmcnt(0)
    v_lshlrev_b32 v112, 16, v156
    v_and_b32 v113, 0xffff0000, v156
    v_lshlrev_b32 v114, 16, v44
    v_and_b32 v115, 0xffff0000, v44
    v_lshlrev_b32 v116, 16, v157
    v_and_b32 v117, 0xffff0000, v157
    v_lshlrev_b32 v118, 16, v45
    v_and_b32 v119, 0xffff0000, v45
    v_lshlrev_b32 v120, 16, v158
    v_and_b32 v121, 0xffff0000, v158
    v_lshlrev_b32 v122, 16, v46
    v_and_b32 v123, 0xffff0000, v46
    v_lshlrev_b32 v124, 16, v159
    v_and_b32 v125, 0xffff0000, v159
    v_lshlrev_b32 v126, 16, v47
    v_and_b32 v127, 0xffff0000, v47
    v_mul_f32 v112, v112, v114
    v_mul_f32 v113, v113, v115
    v_mul_f32 v116, v116, v118
    v_mul_f32 v117, v117, v119
    v_mul_f32 v120, v120, v122
    v_mul_f32 v121, v121, v123
    v_mul_f32 v124, v124, v126
    v_mul_f32 v125, v125, v127
    v_cvt_pk_bf16_f32 v156, v112, v113
    v_cvt_pk_bf16_f32 v157, v116, v117
    v_cvt_pk_bf16_f32 v158, v120, v121
    v_cvt_pk_bf16_f32 v159, v124, v125
    buffer_store_dwordx4 v[156:159], v13, s[8:11], s19 offen sc1
K2_END:
    s_endpgm
.globl k3_kernel
.p2align 8
.type k3_kernel,@function
k3_kernel:
    s_cmp_ge_u32 s2, 256
    s_cbranch_scc1 K3_END
    s_load_dwordx2 s[4:5], s[0:1], 88
    s_load_dwordx2 s[6:7], s[0:1], 0
    s_load_dwordx2 s[18:19], s[0:1], 72
    v_lshrrev_b32 v2, 6, v0
    v_and_b32 v0, 63, v0
    v_readfirstlane_b32 s20, v2
    s_and_b32 s21, s2, 7
    s_lshr_b32 s22, s2, 3
    s_lshr_b32 s26, s21, 2
    s_and_b32 s27, s21, 3
    s_lshl_b32 s27, s27, 2
    s_and_b32 s23, s22, 3
    s_add_u32 s27, s27, s23
    s_lshr_b32 s28, s22, 2
    v_lshlrev_b32 v8, 4, v0
    s_lshl_b32 s23, s26, 5
    s_lshl_b32 s24, s27, 1
    s_add_u32 s23, s23, s24
    s_and_b32 s25, s20, 1
    s_add_u32 s24, s23, s25
    s_lshl_b32 s29, s24, 11
    s_add_u32 s29, s29, 14123008
    s_cmp_ge_u32 s20, 2
    s_cbranch_scc1 K3A_1
    s_lshl_b32 s23, s28, 1
    s_add_u32 s23, s23, s25
    s_mul_i32 s30, s23, 33792
    s_add_u32 s30, s30, 13582336
    s_lshl_b32 s24, s26, 4
    s_add_u32 s23, s23, s24
    s_mul_i32 s31, s23, 66560
    s_add_u32 s31, s31, 18513920
    s_branch K3B_2
K3A_1:
    s_mul_i32 s30, s24, 33792
    s_add_u32 s30, s30, 8650752
    s_mul_i32 s31, s24, 66560
    s_add_u32 s31, s31, 14254080
K3B_2:
    s_mul_i32 s32, s20, 4096
    s_waitcnt lgkmcnt(0)
    s_mov_b32 s8, s4
    s_mov_b32 s9, s5
    s_mov_b32 s10, 20643840
    s_mov_b32 s11, 131072
    s_add_u32 m0, s32, 0
    s_nop 0
    buffer_load_dwordx4 v8, s[8:11], s30 offen offset:0 lds
    buffer_load_dwordx4 v8, s[8:11], s30 offen offset:1024 lds
    buffer_load_dwordx4 v8, s[8:11], s30 offen offset:2048 lds
    buffer_load_dwordx4 v8, s[8:11], s30 offen offset:3072 lds
    s_add_u32 s30, s30, 4096
    s_add_u32 m0, s32, 16384
    s_nop 0
    buffer_load_dwordx4 v8, s[8:11], s30 offen offset:0 lds
    buffer_load_dwordx4 v8, s[8:11], s30 offen offset:1024 lds
    buffer_load_dwordx4 v8, s[8:11], s30 offen offset:2048 lds
    buffer_load_dwordx4 v8, s[8:11], s30 offen offset:3072 lds
    s_add_u32 s30, s30, 4096
    s_add_u32 m0, s32, 32768
    s_nop 0
    buffer_load_dwordx4 v8, s[8:11], s30 offen offset:0 lds
    buffer_load_dwordx4 v8, s[8:11], s30 offen offset:1024 lds
    buffer_load_dwordx4 v8, s[8:11], s30 offen offset:2048 lds
    buffer_load_dwordx4 v8, s[8:11], s30 offen offset:3072 lds
    s_add_u32 s30, s30, 4096
    s_add_u32 m0, s32, 49152
    s_nop 0
    buffer_load_dwordx4 v8, s[8:11], s30 offen offset:0 lds
    buffer_load_dwordx4 v8, s[8:11], s30 offen offset:1024 lds
    buffer_load_dwordx4 v8, s[8:11], s30 offen offset:2048 lds
    buffer_load_dwordx4 v8, s[8:11], s30 offen offset:3072 lds
    s_add_u32 s30, s30, 4096
    s_lshr_b32 s23, s20, 1
    s_mul_i32 s23, s23, 4096
    v_add_u32 v10, s23, v8
    s_and_b32 s23, s20, 1
    s_add_u32 s23, s23, 2
    s_mul_i32 s23, s23, 4096
    v_add_u32 v11, s23, v8
    v_add_u32 v14, 49152, v10
    v_add_u32 v15, 49152, v11
    v_add_u32 v16, 98304, v10
    v_add_u32 v17, 98304, v11
    s_mov_b32 s12, s6
    s_mov_b32 s13, s7
    s_mov_b32 s14, 2048000
    s_mov_b32 s15, 131072
    s_mov_b32 s16, s18
    s_mov_b32 s17, s19
    s_mov_b32 s18, 2048000
    s_mov_b32 s19, 131072
    v_and_b32 v2, 31, v0
    v_lshlrev_b32 v9, 2, v2
    v_lshrrev_b32 v2, 3, v0
    v_and_b32 v3, 7, v0
    v_xor_b32 v4, v3, v2
    s_lshl_b32 s23, s20, 4
    s_lshl_b32 s24, s27, 6
    s_add_u32 s23, s23, s24
    v_add_u32 v2, s23, v2
    s_mul_i32 s23, s26, 1000
    s_lshl_b32 s24, s28, 7
    v_add_u32 v5, 0, v2
    v_add_u32 v6, s23, v5
    v_lshlrev_b32 v6, 10, v6
    v_lshl_add_u32 v6, v4, 4, v6
    v_add_u32 v6, s24, v6
    v_cmp_gt_u32 vcc, 1000, v5
    v_mov_b32 v5, 0x7ffffff0
    s_nop 0
    v_cndmask_b32 v12, v5, v6, vcc
    v_add_u32 v5, 8, v2
    v_add_u32 v6, s23, v5
    v_lshlrev_b32 v6, 10, v6
    v_lshl_add_u32 v6, v4, 4, v6
    v_add_u32 v6, s24, v6
    v_cmp_gt_u32 vcc, 1000, v5
    v_mov_b32 v5, 0x7ffffff0
    s_nop 0
    v_cndmask_b32 v13, v5, v6, vcc
    s_waitcnt vmcnt(12)
    s_barrier
    ds_read_b128 v[32:35], v10 offset:0
    ds_read_b128 v[36:39], v11 offset:0
    ds_read_b128 v[40:43], v10 offset:1024
    ds_read_b128 v[44:47], v11 offset:1024
    s_waitcnt lgkmcnt(2)
    v_mfma_f32_32x32x16_bf16 v[64:79], v[32:35], v[36:39], 0
    s_add_u32 m0, s32, 65536
    s_nop 0
    buffer_load_dwordx4 v8, s[8:11], s30 offen offset:0 lds
    ds_read_b128 v[32:35], v10 offset:2048
    ds_read_b128 v[36:39], v11 offset:2048
    s_waitcnt lgkmcnt(2)
    v_mfma_f32_32x32x16_bf16 v[64:79], v[40:43], v[44:47], v[64:79]
    buffer_load_dwordx4 v8, s[8:11], s30 offen offset:1024 lds
    ds_read_b128 v[40:43], v10 offset:3072
    ds_read_b128 v[44:47], v11 offset:3072
    s_waitcnt lgkmcnt(2)
    v_mfma_f32_32x32x16_bf16 v[64:79], v[32:35], v[36:39], v[64:79]
    buffer_load_dwordx4 v8, s[8:11], s30 offen offset:2048 lds
    buffer_load_dword v112, v9, s[8:11], s29 offen offset:0
    buffer_load_dword v120, v9, s[8:11], s29 offen offset:128
    buffer_load_dword v113, v9, s[8:11], s29 offen offset:256
    buffer_load_dword v121, v9, s[8:11], s29 offen offset:384
    buffer_load_dword v114, v9, s[8:11], s29 offen offset:512
    buffer_load_dword v122, v9, s[8:11], s29 offen offset:640
    buffer_load_dword v115, v9, s[8:11], s29 offen offset:768
    buffer_load_dword v123, v9, s[8:11], s29 offen offset:896
    buffer_load_dword v116, v9, s[8:11], s29 offen offset:1024
    buffer_load_dword v124, v9, s[8:11], s29 offen offset:1152
    buffer_load_dword v117, v9, s[8:11], s29 offen offset:1280
    buffer_load_dword v125, v9, s[8:11], s29 offen offset:1408
    buffer_load_dword v118, v9, s[8:11], s29 offen offset:1536
    buffer_load_dword v126, v9, s[8:11], s29 offen offset:1664
    buffer_load_dword v119, v9, s[8:11], s29 offen offset:1792
    buffer_load_dword v127, v9, s[8:11], s29 offen offset:1920
    s_waitcnt vmcnt(27)
    s_barrier
    ds_read_b128 v[32:35], v10 offset:16384
    ds_read_b128 v[36:39], v11 offset:16384
    s_waitcnt lgkmcnt(2)
    v_mfma_f32_32x32x16_bf16 v[64:79], v[40:43], v[44:47], v[64:79]
    buffer_load_dwordx4 v8, s[8:11], s30 offen offset:3072 lds
    s_add_u32 s30, s30, 4096
    ds_read_b128 v[40:43], v10 offset:17408
    ds_read_b128 v[44:47], v11 offset:17408
    s_waitcnt lgkmcnt(2)
    v_mfma_f32_32x32x16_bf16 v[64:79], v[32:35], v[36:39], v[64:79]
    s_add_u32 m0, s32, 81920
    s_nop 0
    buffer_load_dwordx4 v8, s[8:11], s30 offen offset:0 lds
    ds_read_b128 v[32:35], v10 offset:18432
    ds_read_b128 v[36:39], v11 offset:18432
    s_waitcnt lgkmcnt(2)
    v_mfma_f32_32x32x16_bf16 v[64:79], v[40:43], v[44:47], v[64:79]
    buffer_load_dwordx4 v8, s[8:11], s30 offen offset:1024 lds
    ds_read_b128 v[40:43], v10 offset:19456
    ds_read_b128 v[44:47], v11 offset:19456
    s_waitcnt lgkmcnt(2)
    v_mfma_f32_32x32x16_bf16 v[64:79], v[32:35], v[36:39], v[64:79]
    buffer_load_dwordx4 v8, s[8:11], s30 offen offset:2048 lds
    s_waitcnt vmcnt(27)
    s_barrier
    ds_read_b128 v[32:35], v10 offset:32768
    ds_read_b128 v[36:39], v11 offset:32768
    s_waitcnt lgkmcnt(2)
    v_mfma_f32_32x32x16_bf16 v[64:79], v[40:43], v[44:47], v[64:79]
    buffer_load_dwordx4 v8, s[8:11], s30 offen offset:3072 lds
    s_add_u32 s30, s30, 4096
    ds_read_b128 v[40:43], v10 offset:33792
    ds_read_b128 v[44:47], v11 offset:33792
    s_waitcnt lgkmcnt(2)
    v_mfma_f32_32x32x16_bf16 v[64:79], v[32:35], v[36:39], v[64:79]
    s_add_u32 m0, s32, 0
    s_nop 0
    buffer_load_dwordx4 v8, s[8:11], s30 offen offset:0 lds
    ds_read_b128 v[32:35], v10 offset:34816
    ds_read_b128 v[36:39], v11 offset:34816
    s_waitcnt lgkmcnt(2)
    v_mfma_f32_32x32x16_bf16 v[64:79], v[40:43], v[44:47], v[64:79]
    buffer_load_dwordx4 v8, s[8:11], s30 offen offset:1024 lds
    ds_read_b128 v[40:43], v10 offset:35840
    ds_read_b128 v[44:47], v11 offset:35840
    s_waitcnt lgkmcnt(2)
    v_mfma_f32_32x32x16_bf16 v[64:79], v[32:35], v[36:39], v[64:79]
    buffer_load_dwordx4 v8, s[8:11], s30 offen offset:2048 lds
    s_waitcnt vmcnt(27)
    s_barrier
    ds_read_b128 v[32:35], v14 offset:0
    ds_read_b128 v[36:39], v15 offset:0
    s_waitcnt lgkmcnt(2)
    v_mfma_f32_32x32x16_bf16 v[64:79], v[40:43], v[44:47], v[64:79]
    buffer_load_dwordx4 v8, s[8:11], s30 offen offset:3072 lds
    s_add_u32 s30, s30, 4096
    ds_read_b128 v[40:43], v14 offset:1024
    ds_read_b128 v[44:47], v15 offset:1024
    s_waitcnt lgkmcnt(2)
    v_mfma_f32_32x32x16_bf16 v[64:79], v[32:35], v[36:39], v[64:79]
    s_add_u32 m0, s32, 16384
    s_nop 0
    buffer_load_dwordx4 v8, s[8:11], s30 offen offset:0 lds
    ds_read_b128 v[32:35], v14 offset:2048
    ds_read_b128 v[36:39], v15 offset:2048
    s_waitcnt lgkmcnt(2)
    v_mfma_f32_32x32x16_bf16 v[64:79], v[40:43], v[44:47], v[64:79]
    buffer_load_dwordx4 v8, s[8:11], s30 offen offset:1024 lds
    ds_read_b128 v[40:43], v14 offset:3072
    ds_read_b128 v[44:47], v15 offset:3072
    s_waitcnt lgkmcnt(2)
    v_mfma_f32_32x32x16_bf16 v[64:79], v[32:35], v[36:39], v[64:79]
    buffer_load_dwordx4 v8, s[8:11], s30 offen offset:2048 lds
    s_waitcnt vmcnt(11)
    s_barrier
    ds_read_b128 v[32:35], v14 offset:16384
    ds_read_b128 v[36:39], v15 offset:16384
    s_waitcnt lgkmcnt(2)
    v_mfma_f32_32x32x16_bf16 v[64:79], v[40:43], v[44:47], v[64:79]
    buffer_load_dwordx4 v8, s[8:11], s30 offen offset:3072 lds
    s_add_u32 s30, s30, 4096
    ds_read_b128 v[40:43], v14 offset:17408
    ds_read_b128 v[44:47], v15 offset:17408
    s_waitcnt lgkmcnt(2)
    v_mfma_f32_32x32x16_bf16 v[64:79], v[32:35], v[36:39], v[64:79]
    s_add_u32 m0, s32, 32768
    s_nop 0
    buffer_load_dwordx4 v8, s[8:11], s31 offen offset:0 lds
    s_waitcnt vmcnt(14)
    v_max3_f32 v2, v112, v113, v114
    v_max3_f32 v3, v115, v116, v117
    v_max3_f32 v2, v2, v118, v119
    v_max_f32 v2, v2, v3
    ds_read_b128 v[32:35], v14 offset:18432
    ds_read_b128 v[36:39], v15 offset:18432
    s_waitcnt lgkmcnt(2)
    v_mfma_f32_32x32x16_bf16 v[64:79], v[40:43], v[44:47], v[64:79]
    buffer_load_dwordx4 v8, s[8:11], s31 offen offset:1024 lds
    v_sub_f32 v112, v112, v2
    v_sub_f32 v113, v113, v2
    v_sub_f32 v114, v114, v2
    v_sub_f32 v115, v115, v2
    ds_read_b128 v[40:43], v14 offset:19456
    ds_read_b128 v[44:47], v15 offset:19456
    s_waitcnt lgkmcnt(2)
    v_mfma_f32_32x32x16_bf16 v[64:79], v[32:35], v[36:39], v[64:79]
    buffer_load_dwordx4 v8, s[8:11], s31 offen offset:2048 lds
    v_sub_f32 v116, v116, v2
    v_sub_f32 v117, v117, v2
    v_sub_f32 v118, v118, v2
    v_sub_f32 v119, v119, v2
    s_waitcnt vmcnt(11)
    s_barrier
    ds_read_b128 v[32:35], v14 offset:32768
    ds_read_b128 v[36:39], v15 offset:32768
    s_waitcnt lgkmcnt(2)
    v_mfma_f32_32x32x16_bf16 v[64:79], v[40:43], v[44:47], v[64:79]
    buffer_load_dwordx4 v8, s[8:11], s31 offen offset:3072 lds
    s_add_u32 s31, s31, 4096
    v_exp_f32 v112, v112
    v_exp_f32 v113, v113
    v_exp_f32 v114, v114
    v_exp_f32 v115, v115
    ds_read_b128 v[40:43], v14 offset:33792
    ds_read_b128 v[44:47], v15 offset:33792
    s_waitcnt lgkmcnt(2)
    v_mfma_f32_32x32x16_bf16 v[64:79], v[32:35], v[36:39], v[64:79]
    s_add_u32 m0, s32, 49152
    s_nop 0
    buffer_load_dwordx4 v8, s[8:11], s31 offen offset:0 lds
    v_exp_f32 v116, v116
    v_exp_f32 v117, v117
    v_exp_f32 v118, v118
    v_exp_f32 v119, v119
    ds_read_b128 v[32:35], v14 offset:34816
    ds_read_b128 v[36:39], v15 offset:34816
    s_waitcnt lgkmcnt(2)
    v_mfma_f32_32x32x16_bf16 v[64:79], v[40:43], v[44:47], v[64:79]
    buffer_load_dwordx4 v8, s[8:11], s31 offen offset:1024 lds
    v_mul_f32 v3, v112, v120
    v_mul_f32 v2, v113, v121
    v_fmac_f32 v3, v114, v122
    v_fmac_f32 v2, v115, v123
    ds_read_b128 v[40:43], v14 offset:35840
    ds_read_b128 v[44:47], v15 offset:35840
    s_waitcnt lgkmcnt(2)
    v_mfma_f32_32x32x16_bf16 v[64:79], v[32:35], v[36:39], v[64:79]
    buffer_load_dwordx4 v8, s[8:11], s31 offen offset:2048 lds
    v_fmac_f32 v3, v116, v124
    v_fmac_f32 v2, v117, v125
    v_fmac_f32 v3, v118, v126
    v_fmac_f32 v2, v119, v127
    s_waitcnt vmcnt(11)
    s_barrier
    ds_read_b128 v[32:35], v10 offset:0
    ds_read_b128 v[36:39], v11 offset:0
    s_waitcnt lgkmcnt(2)
    v_mfma_f32_32x32x16_bf16 v[64:79], v[40:43], v[44:47], v[64:79]
    buffer_load_dwordx4 v8, s[8:11], s31 offen offset:3072 lds
    s_add_u32 s31, s31, 4096
    v_add_f32 v3, v3, v2
    v_rcp_f32 v3, v3
    s_nop 0
    v_mul_f32 v112, v112, v3
    v_mul_f32 v113, v113, v3
    ds_read_b128 v[40:43], v10 offset:1024
    ds_read_b128 v[44:47], v11 offset:1024
    s_waitcnt lgkmcnt(2)
    v_mfma_f32_32x32x16_bf16 v[64:79], v[32:35], v[36:39], v[64:79]
    s_add_u32 m0, s32, 65536
    s_nop 0
    buffer_load_dwordx4 v8, s[8:11], s31 offen offset:0 lds
    v_mul_f32 v114, v114, v3
    v_mul_f32 v115, v115, v3
    v_mul_f32 v116, v116, v3
    v_mul_f32 v117, v117, v3
    ds_read_b128 v[32:35], v10 offset:2048
    ds_read_b128 v[36:39], v11 offset:2048
    s_waitcnt lgkmcnt(2)
    v_mfma_f32_32x32x16_bf16 v[64:79], v[40:43], v[44:47], v[64:79]
    buffer_load_dwordx4 v8, s[8:11], s31 offen offset:1024 lds
    v_mul_f32 v118, v118, v3
    v_mul_f32 v119, v119, v3
    ds_read_b128 v[40:43], v10 offset:3072
    ds_read_b128 v[44:47], v11 offset:3072
    s_waitcnt lgkmcnt(2)
    v_mfma_f32_32x32x16_bf16 v[64:79], v[32:35], v[36:39], v[64:79]
    buffer_load_dwordx4 v8, s[8:11], s31 offen offset:2048 lds
    s_waitcnt vmcnt(11)
    s_barrier
    ds_read_b128 v[32:35], v10 offset:16384
    ds_read_b128 v[36:39], v11 offset:16384
    s_waitcnt lgkmcnt(2)
    v_mfma_f32_32x32x16_bf16 v[64:79], v[40:43], v[44:47], v[64:79]
    buffer_load_dwordx4 v8, s[8:11], s31 offen offset:3072 lds
    s_add_u32 s31, s31, 4096
    ds_read_b128 v[40:43], v10 offset:17408
    ds_read_b128 v[44:47], v11 offset:17408
    s_waitcnt lgkmcnt(2)
    v_mfma_f32_32x32x16_bf16 v[64:79], v[32:35], v[36:39], v[64:79]
    s_add_u32 m0, s32, 81920
    s_nop 0
    buffer_load_dwordx4 v8, s[8:11], s31 offen offset:0 lds
    ds_read_b128 v[32:35], v10 offset:18432
    ds_read_b128 v[36:39], v11 offset:18432
    s_waitcnt lgkmcnt(2)
    v_mfma_f32_32x32x16_bf16 v[64:79], v[40:43], v[44:47], v[64:79]
    buffer_load_dwordx4 v8, s[8:11], s31 offen offset:1024 lds
    ds_read_b128 v[40:43], v10 offset:19456
    ds_read_b128 v[44:47], v11 offset:19456
    s_waitcnt lgkmcnt(2)
    v_mfma_f32_32x32x16_bf16 v[64:79], v[32:35], v[36:39], v[64:79]
    buffer_load_dwordx4 v8, s[8:11], s31 offen offset:2048 lds
    s_waitcnt vmcnt(11)
    s_barrier
    ds_read_b128 v[32:35], v10 offset:32768
    ds_read_b128 v[36:39], v11 offset:32768
    s_waitcnt lgkmcnt(2)
    v_mfma_f32_32x32x16_bf16 v[64:79], v[40:43], v[44:47], v[64:79]
    buffer_load_dwordx4 v8, s[8:11], s31 offen offset:3072 lds
    s_add_u32 s31, s31, 4096
    ds_read_b128 v[40:43], v10 offset:33792
    ds_read_b128 v[44:47], v11 offset:33792
    s_waitcnt lgkmcnt(2)
    v_mfma_f32_32x32x16_bf16 v[80:95], v[32:35], v[36:39], 0
    s_add_u32 m0, s32, 0
    s_nop 0
    buffer_load_dwordx4 v8, s[8:11], s31 offen offset:0 lds
    ds_read_b128 v[32:35], v10 offset:34816
    ds_read_b128 v[36:39], v11 offset:34816
    s_waitcnt lgkmcnt(2)
    v_mfma_f32_32x32x16_bf16 v[80:95], v[40:43], v[44:47], v[80:95]
    buffer_load_dwordx4 v8, s[8:11], s31 offen offset:1024 lds
    ds_read_b128 v[40:43], v10 offset:35840
    ds_read_b128 v[44:47], v11 offset:35840
    s_waitcnt lgkmcnt(2)
    v_mfma_f32_32x32x16_bf16 v[80:95], v[32:35], v[36:39], v[80:95]
    buffer_load_dwordx4 v8, s[8:11], s31 offen offset:2048 lds
    s_waitcnt vmcnt(11)
    s_barrier
    ds_read_b128 v[32:35], v14 offset:0
    ds_read_b128 v[36:39], v15 offset:0
    s_waitcnt lgkmcnt(2)
    v_mfma_f32_32x32x16_bf16 v[80:95], v[40:43], v[44:47], v[80:95]
    buffer_load_dwordx4 v8, s[8:11], s31 offen offset:3072 lds
    s_add_u32 s31, s31, 4096
    ds_read_b128 v[40:43], v14 offset:1024
    ds_read_b128 v[44:47], v15 offset:1024
    s_waitcnt lgkmcnt(2)
    v_mfma_f32_32x32x16_bf16 v[80:95], v[32:35], v[36:39], v[80:95]
    s_add_u32 m0, s32, 16384
    s_nop 0
    buffer_load_dwordx4 v8, s[8:11], s31 offen offset:0 lds
    ds_read_b128 v[32:35], v14 offset:2048
    ds_read_b128 v[36:39], v15 offset:2048
    s_waitcnt lgkmcnt(2)
    v_mfma_f32_32x32x16_bf16 v[80:95], v[40:43], v[44:47], v[80:95]
    buffer_load_dwordx4 v8, s[8:11], s31 offen offset:1024 lds
    ds_read_b128 v[40:43], v14 offset:3072
    ds_read_b128 v[44:47], v15 offset:3072
    s_waitcnt lgkmcnt(2)
    v_mfma_f32_32x32x16_bf16 v[80:95], v[32:35], v[36:39], v[80:95]
    buffer_load_dwordx4 v8, s[8:11], s31 offen offset:2048 lds
    s_waitcnt vmcnt(11)
    s_barrier
    ds_read_b128 v[32:35], v14 offset:16384
    ds_read_b128 v[36:39], v15 offset:16384
    s_waitcnt lgkmcnt(2)
    v_mfma_f32_32x32x16_bf16 v[80:95], v[40:43], v[44:47], v[80:95]
    buffer_load_dwordx4 v8, s[8:11], s31 offen offset:3072 lds
    s_add_u32 s31, s31, 4096
    ds_read_b128 v[40:43], v14 offset:17408
    ds_read_b128 v[44:47], v15 offset:17408
    s_waitcnt lgkmcnt(2)
    v_mfma_f32_32x32x16_bf16 v[96:111], v[32:35], v[36:39], 0
    s_add_u32 m0, s32, 32768
    s_nop 0
    buffer_load_dwordx4 v8, s[8:11], s31 offen offset:0 lds
    ds_read_b128 v[32:35], v14 offset:18432
    ds_read_b128 v[36:39], v15 offset:18432
    s_waitcnt lgkmcnt(2)
    v_mfma_f32_32x32x16_bf16 v[96:111], v[40:43], v[44:47], v[96:111]
    buffer_load_dwordx4 v8, s[8:11], s31 offen offset:1024 lds
    ds_read_b128 v[40:43], v14 offset:19456
    ds_read_b128 v[44:47], v15 offset:19456
    s_waitcnt lgkmcnt(2)
    v_mfma_f32_32x32x16_bf16 v[96:111], v[32:35], v[36:39], v[96:111]
    buffer_load_dwordx4 v8, s[8:11], s31 offen offset:2048 lds
    v_fmac_f32 v64, v80, v112
    v_fmac_f32 v65, v81, v112
    v_fmac_f32 v66, v82, v112
    v_fmac_f32 v67, v83, v112
    s_waitcnt vmcnt(11)
    s_barrier
    ds_read_b128 v[32:35], v14 offset:32768
    ds_read_b128 v[36:39], v15 offset:32768
    s_waitcnt lgkmcnt(2)
    v_mfma_f32_32x32x16_bf16 v[96:111], v[40:43], v[44:47], v[96:111]
    buffer_load_dwordx4 v8, s[8:11], s31 offen offset:3072 lds
    s_add_u32 s31, s31, 4096
    v_fmac_f32 v68, v84, v112
    v_fmac_f32 v69, v85, v112
    v_fmac_f32 v70, v86, v112
    v_fmac_f32 v71, v87, v112
    ds_read_b128 v[40:43], v14 offset:33792
    ds_read_b128 v[44:47], v15 offset:33792
    s_waitcnt lgkmcnt(2)
    v_mfma_f32_32x32x16_bf16 v[96:111], v[32:35], v[36:39], v[96:111]
    s_add_u32 m0, s32, 49152
    s_nop 0
    buffer_load_dwordx4 v8, s[8:11], s31 offen offset:0 lds
    v_fmac_f32 v72, v88, v112
    v_fmac_f32 v73, v89, v112
    v_fmac_f32 v74, v90, v112
    v_fmac_f32 v75, v91, v112
    ds_read_b128 v[32:35], v14 offset:34816
    ds_read_b128 v[36:39], v15 offset:34816
    s_waitcnt lgkmcnt(2)
    v_mfma_f32_32x32x16_bf16 v[96:111], v[40:43], v[44:47], v[96:111]
    buffer_load_dwordx4 v8, s[8:11], s31 offen offset:1024 lds
    v_fmac_f32 v76, v92, v112
    v_fmac_f32 v77, v93, v112
    v_fmac_f32 v78, v94, v112
    v_fmac_f32 v79, v95, v112
    ds_read_b128 v[40:43], v14 offset:35840
    ds_read_b128 v[44:47], v15 offset:35840
    s_waitcnt lgkmcnt(2)
    v_mfma_f32_32x32x16_bf16 v[96:111], v[32:35], v[36:39], v[96:111]
    buffer_load_dwordx4 v8, s[8:11], s31 offen offset:2048 lds
    s_waitcnt vmcnt(11)
    s_barrier
    ds_read_b128 v[32:35], v10 offset:0
    ds_read_b128 v[36:39], v11 offset:0
    s_waitcnt lgkmcnt(2)
    v_mfma_f32_32x32x16_bf16 v[96:111], v[40:43], v[44:47], v[96:111]
    buffer_load_dwordx4 v8, s[8:11], s31 offen offset:3072 lds
    s_add_u32 s31, s31, 4096
    ds_read_b128 v[40:43], v10 offset:1024
    ds_read_b128 v[44:47], v11 offset:1024
    s_waitcnt lgkmcnt(2)
    v_mfma_f32_32x32x16_bf16 v[80:95], v[32:35], v[36:39], 0
    s_add_u32 m0, s32, 65536
    s_nop 0
    buffer_load_dwordx4 v8, s[8:11], s31 offen offset:0 lds
    ds_read_b128 v[32:35], v10 offset:2048
    ds_read_b128 v[36:39], v11 offset:2048
    s_waitcnt lgkmcnt(2)
    v_mfma_f32_32x32x16_bf16 v[80:95], v[40:43], v[44:47], v[80:95]
    buffer_load_dwordx4 v8, s[8:11], s31 offen offset:1024 lds
    ds_read_b128 v[40:43], v10 offset:3072
    ds_read_b128 v[44:47], v11 offset:3072
    s_waitcnt lgkmcnt(2)
    v_mfma_f32_32x32x16_bf16 v[80:95], v[32:35], v[36:39], v[80:95]
    buffer_load_dwordx4 v8, s[8:11], s31 offen offset:2048 lds
    v_fmac_f32 v64, v96, v113
    v_fmac_f32 v65, v97, v113
    v_fmac_f32 v66, v98, v113
    v_fmac_f32 v67, v99, v113
    s_waitcnt vmcnt(11)
    s_barrier
    ds_read_b128 v[32:35], v10 offset:16384
    ds_read_b128 v[36:39], v11 offset:16384
    s_waitcnt lgkmcnt(2)
    v_mfma_f32_32x32x16_bf16 v[80:95], v[40:43], v[44:47], v[80:95]
    buffer_load_dwordx4 v8, s[8:11], s31 offen offset:3072 lds
    s_add_u32 s31, s31, 4096
    v_fmac_f32 v68, v100, v113
    v_fmac_f32 v69, v101, v113
    v_fmac_f32 v70, v102, v113
    v_fmac_f32 v71, v103, v113
    ds_read_b128 v[40:43], v10 offset:17408
    ds_read_b128 v[44:47], v11 offset:17408
    s_waitcnt lgkmcnt(2)
    v_mfma_f32_32x32x16_bf16 v[80:95], v[32:35], v[36:39], v[80:95]
    s_add_u32 m0, s32, 81920
    s_nop 0
    buffer_load_dwordx4 v8, s[8:11], s31 offen offset:0 lds
    v_fmac_f32 v72, v104, v113
    v_fmac_f32 v73, v105, v113
    v_fmac_f32 v74, v106, v113
    v_fmac_f32 v75, v107, v113
    ds_read_b128 v[32:35], v10 offset:18432
    ds_read_b128 v[36:39], v11 offset:18432
    s_waitcnt lgkmcnt(2)
    v_mfma_f32_32x32x16_bf16 v[80:95], v[40:43], v[44:47], v[80:95]
    buffer_load_dwordx4 v8, s[8:11], s31 offen offset:1024 lds
    v_fmac_f32 v76, v108, v113
    v_fmac_f32 v77, v109, v113
    v_fmac_f32 v78, v110, v113
    v_fmac_f32 v79, v111, v113
    ds_read_b128 v[40:43], v10 offset:19456
    ds_read_b128 v[44:47], v11 offset:19456
    s_waitcnt lgkmcnt(2)
    v_mfma_f32_32x32x16_bf16 v[80:95], v[32:35], v[36:39], v[80:95]
    buffer_load_dwordx4 v8, s[8:11], s31 offen offset:2048 lds
    s_waitcnt vmcnt(11)
    s_barrier
    ds_read_b128 v[32:35], v10 offset:32768
    ds_read_b128 v[36:39], v11 offset:32768
    s_waitcnt lgkmcnt(2)
    v_mfma_f32_32x32x16_bf16 v[80:95], v[40:43], v[44:47], v[80:95]
    buffer_load_dwordx4 v8, s[8:11], s31 offen offset:3072 lds
    s_add_u32 s31, s31, 4096
    ds_read_b128 v[40:43], v10 offset:33792
    ds_read_b128 v[44:47], v11 offset:33792
    s_waitcnt lgkmcnt(2)
    v_mfma_f32_32x32x16_bf16 v[96:111], v[32:35], v[36:39], 0
    s_add_u32 m0, s32, 0
    s_nop 0
    buffer_load_dwordx4 v8, s[8:11], s31 offen offset:0 lds
    ds_read_b128 v[32:35], v10 offset:34816
    ds_read_b128 v[36:39], v11 offset:34816
    s_waitcnt lgkmcnt(2)
    v_mfma_f32_32x32x16_bf16 v[96:111], v[40:43], v[44:47], v[96:111]
    buffer_load_dwordx4 v8, s[8:11], s31 offen offset:1024 lds
    ds_read_b128 v[40:43], v10 offset:35840
    ds_read_b128 v[44:47], v11 offset:35840
    s_waitcnt lgkmcnt(2)
    v_mfma_f32_32x32x16_bf16 v[96:111], v[32:35], v[36:39], v[96:111]
    buffer_load_dwordx4 v8, s[8:11], s31 offen offset:2048 lds
    v_fmac_f32 v64, v80, v114
    v_fmac_f32 v65, v81, v114
    v_fmac_f32 v66, v82, v114
    v_fmac_f32 v67, v83, v114
    s_waitcnt vmcnt(11)
    s_barrier
    ds_read_b128 v[32:35], v14 offset:0
    ds_read_b128 v[36:39], v15 offset:0
    s_waitcnt lgkmcnt(2)
    v_mfma_f32_32x32x16_bf16 v[96:111], v[40:43], v[44:47], v[96:111]
    buffer_load_dwordx4 v8, s[8:11], s31 offen offset:3072 lds
    s_add_u32 s31, s31, 4096
    v_fmac_f32 v68, v84, v114
    v_fmac_f32 v69, v85, v114
    v_fmac_f32 v70, v86, v114
    v_fmac_f32 v71, v87, v114
    ds_read_b128 v[40:43], v14 offset:1024
    ds_read_b128 v[44:47], v15 offset:1024
    s_waitcnt lgkmcnt(2)
    v_mfma_f32_32x32x16_bf16 v[96:111], v[32:35], v[36:39], v[96:111]
    s_add_u32 m0, s32, 16384
    s_nop 0
    buffer_load_dwordx4 v8, s[8:11], s31 offen offset:0 lds
    v_fmac_f32 v72, v88, v114
    v_fmac_f32 v73, v89, v114
    v_fmac_f32 v74, v90, v114
    v_fmac_f32 v75, v91, v114
    ds_read_b128 v[32:35], v14 offset:2048
    ds_read_b128 v[36:39], v15 offset:2048
    s_waitcnt lgkmcnt(2)
    v_mfma_f32_32x32x16_bf16 v[96:111], v[40:43], v[44:47], v[96:111]
    buffer_load_dwordx4 v8, s[8:11], s31 offen offset:1024 lds
    v_fmac_f32 v76, v92, v114
    v_fmac_f32 v77, v93, v114
    v_fmac_f32 v78, v94, v114
    v_fmac_f32 v79, v95, v114
    ds_read_b128 v[40:43], v14 offset:3072
    ds_read_b128 v[44:47], v15 offset:3072
    s_waitcnt lgkmcnt(2)
    v_mfma_f32_32x32x16_bf16 v[96:111], v[32:35], v[36:39], v[96:111]
    buffer_load_dwordx4 v8, s[8:11], s31 offen offset:2048 lds
    v_and_b32 v2, 31, v0
    v_lshrrev_b32 v3, 5, v0
    s_lshr_b32 s23, s20, 1
    s_lshl_b32 s23, s23, 2
    v_or_b32 v3, s23, v3
    v_and_b32 v4, 7, v2
    s_waitcnt vmcnt(11)
    s_barrier
    ds_read_b128 v[32:35], v14 offset:16384
    ds_read_b128 v[36:39], v15 offset:16384
    s_waitcnt lgkmcnt(2)
    v_mfma_f32_32x32x16_bf16 v[96:111], v[40:43], v[44:47], v[96:111]
    buffer_load_dwordx4 v8, s[8:11], s31 offen offset:3072 lds
    s_add_u32 s31, s31, 4096
    v_xor_b32 v3, v3, v4
    s_and_b32 s23, s20, 1
    s_lshl_b32 s23, s23, 12
    s_add_u32 s23, s23, 98304
    v_lshlrev_b32 v2, 7, v2
    v_add_u32 v2, s23, v2
    v_lshl_add_u32 v18, v3, 4, v2
    v_xor_b32 v3, 2, v3
    ds_read_b128 v[40:43], v14 offset:17408
    ds_read_b128 v[44:47], v15 offset:17408
    s_waitcnt lgkmcnt(2)
    v_mfma_f32_32x32x16_bf16 v[80:95], v[32:35], v[36:39], 0
    s_add_u32 m0, s32, 32768
    s_nop 0
    buffer_load_dwordx4 v8, s[8:11], s31 offen offset:0 lds
    v_lshl_add_u32 v19, v3, 4, v2
    ds_read_b128 v[32:35], v14 offset:18432
    ds_read_b128 v[36:39], v15 offset:18432
    s_waitcnt lgkmcnt(2)
    v_mfma_f32_32x32x16_bf16 v[80:95], v[40:43], v[44:47], v[80:95]
    buffer_load_dwordx4 v8, s[8:11], s31 offen offset:1024 lds
    ds_read_b128 v[40:43], v14 offset:19456
    ds_read_b128 v[44:47], v15 offset:19456
    s_waitcnt lgkmcnt(2)
    v_mfma_f32_32x32x16_bf16 v[80:95], v[32:35], v[36:39], v[80:95]
    buffer_load_dwordx4 v8, s[8:11], s31 offen offset:2048 lds
    v_fmac_f32 v64, v96, v115
    v_fmac_f32 v65, v97, v115
    v_fmac_f32 v66, v98, v115
    v_fmac_f32 v67, v99, v115
    s_waitcnt vmcnt(11)
    s_barrier
    ds_read_b128 v[32:35], v14 offset:32768
    ds_read_b128 v[36:39], v15 offset:32768
    s_waitcnt lgkmcnt(2)
    v_mfma_f32_32x32x16_bf16 v[80:95], v[40:43], v[44:47], v[80:95]
    buffer_load_dwordx4 v8, s[8:11], s31 offen offset:3072 lds
    s_add_u32 s31, s31, 4096
    v_fmac_f32 v68, v100, v115
    v_fmac_f32 v69, v101, v115
    v_fmac_f32 v70, v102, v115
    v_fmac_f32 v71, v103, v115
    ds_read_b128 v[40:43], v14 offset:33792
    ds_read_b128 v[44:47], v15 offset:33792
    s_waitcnt lgkmcnt(2)
    v_mfma_f32_32x32x16_bf16 v[80:95], v[32:35], v[36:39], v[80:95]
    s_add_u32 m0, s32, 49152
    s_nop 0
    buffer_load_dwordx4 v8, s[8:11], s31 offen offset:0 lds
    v_fmac_f32 v72, v104, v115
    v_fmac_f32 v73, v105, v115
    v_fmac_f32 v74, v106, v115
    v_fmac_f32 v75, v107, v115
    ds_read_b128 v[32:35], v14 offset:34816
    ds_read_b128 v[36:39], v15 offset:34816
    s_waitcnt lgkmcnt(2)
    v_mfma_f32_32x32x16_bf16 v[80:95], v[40:43], v[44:47], v[80:95]
    buffer_load_dwordx4 v8, s[8:11], s31 offen offset:1024 lds
    v_fmac_f32 v76, v108, v115
    v_fmac_f32 v77, v109, v115
    v_fmac_f32 v78, v110, v115
    v_fmac_f32 v79, v111, v115
    ds_read_b128 v[40:43], v14 offset:35840
    ds_read_b128 v[44:47], v15 offset:35840
    s_waitcnt lgkmcnt(2)
    v_mfma_f32_32x32x16_bf16 v[80:95], v[32:35], v[36:39], v[80:95]
    buffer_load_dwordx4 v8, s[8:11], s31 offen offset:2048 lds
    s_lshl_b32 s23, s20, 11
    s_add_u32 m0, s23, 98304
    s_nop 0
    buffer_load_dwordx4 v12, s[12:15], 0 offen lds
    s_add_u32 m0, s23, 99328
    s_nop 0
    buffer_load_dwordx4 v13, s[12:15], 0 offen lds
    s_add_u32 m0, s32, 49152
    s_waitcnt vmcnt(13)
    s_barrier
    ds_read_b128 v[32:35], v10 offset:0
    ds_read_b128 v[36:39], v11 offset:0
    s_waitcnt lgkmcnt(2)
    v_mfma_f32_32x32x16_bf16 v[80:95], v[40:43], v[44:47], v[80:95]
    buffer_load_dwordx4 v8, s[8:11], s31 offen offset:3072 lds
    s_add_u32 s31, s31, 4096
    ds_read_b128 v[40:43], v10 offset:1024
    ds_read_b128 v[44:47], v11 offset:1024
    s_waitcnt lgkmcnt(2)
    v_mfma_f32_32x32x16_bf16 v[96:111], v[32:35], v[36:39], 0
    s_add_u32 m0, s32, 65536
    s_nop 0
    buffer_load_dwordx4 v8, s[8:11], s31 offen offset:0 lds
    ds_read_b128 v[32:35], v10 offset:2048
    ds_read_b128 v[36:39], v11 offset:2048
    s_waitcnt lgkmcnt(2)
    v_mfma_f32_32x32x16_bf16 v[96:111], v[40:43], v[44:47], v[96:111]
    buffer_load_dwordx4 v8, s[8:11], s31 offen offset:1024 lds
    ds_read_b128 v[40:43], v10 offset:3072
    ds_read_b128 v[44:47], v11 offset:3072
    s_waitcnt lgkmcnt(2)
    v_mfma_f32_32x32x16_bf16 v[96:111], v[32:35], v[36:39], v[96:111]
    buffer_load_dwordx4 v8, s[8:11], s31 offen offset:2048 lds
    v_fmac_f32 v64, v80, v116
    v_fmac_f32 v65, v81, v116
    v_fmac_f32 v66, v82, v116
    v_fmac_f32 v67, v83, v116
    s_waitcnt vmcnt(13)
    s_barrier
    ds_read_b128 v[32:35], v10 offset:16384
    ds_read_b128 v[36:39], v11 offset:16384
    s_waitcnt lgkmcnt(2)
    v_mfma_f32_32x32x16_bf16 v[96:111], v[40:43], v[44:47], v[96:111]
    buffer_load_dwordx4 v8, s[8:11], s31 offen offset:3072 lds
    s_add_u32 s31, s31, 4096
    v_fmac_f32 v68, v84, v116
    v_fmac_f32 v69, v85, v116
    v_fmac_f32 v70, v86, v116
    v_fmac_f32 v71, v87, v116
    ds_read_b128 v[40:43], v10 offset:17408
    ds_read_b128 v[44:47], v11 offset:17408
    s_waitcnt lgkmcnt(2)
    v_mfma_f32_32x32x16_bf16 v[96:111], v[32:35], v[36:39], v[96:111]
    s_add_u32 m0, s32, 81920
    s_nop 0
    buffer_load_dwordx4 v8, s[8:11], s31 offen offset:0 lds
    v_fmac_f32 v72, v88, v116
    v_fmac_f32 v73, v89, v116
    v_fmac_f32 v74, v90, v116
    v_fmac_f32 v75, v91, v116
    ds_read_b128 v[32:35], v10 offset:18432
    ds_read_b128 v[36:39], v11 offset:18432
    s_waitcnt lgkmcnt(2)
    v_mfma_f32_32x32x16_bf16 v[96:111], v[40:43], v[44:47], v[96:111]
    buffer_load_dwordx4 v8, s[8:11], s31 offen offset:1024 lds
    v_fmac_f32 v76, v92, v116
    v_fmac_f32 v77, v93, v116
    v_fmac_f32 v78, v94, v116
    v_fmac_f32 v79, v95, v116
    ds_read_b128 v[40:43], v10 offset:19456
    ds_read_b128 v[44:47], v11 offset:19456
    s_waitcnt lgkmcnt(2)
    v_mfma_f32_32x32x16_bf16 v[96:111], v[32:35], v[36:39], v[96:111]
    buffer_load_dwordx4 v8, s[8:11], s31 offen offset:2048 lds
    s_waitcnt vmcnt(13)
    s_barrier
    ds_read_b128 v[32:35], v10 offset:32768
    ds_read_b128 v[36:39], v11 offset:32768
    s_waitcnt lgkmcnt(2)
    v_mfma_f32_32x32x16_bf16 v[96:111], v[40:43], v[44:47], v[96:111]
    buffer_load_dwordx4 v8, s[8:11], s31 offen offset:3072 lds
    s_add_u32 s31, s31, 4096
    ds_read_b128 v[40:43], v10 offset:33792
    ds_read_b128 v[44:47], v11 offset:33792
    s_waitcnt lgkmcnt(2)
    v_mfma_f32_32x32x16_bf16 v[80:95], v[32:35], v[36:39], 0
    ds_read_b128 v[32:35], v10 offset:34816
    ds_read_b128 v[36:39], v11 offset:34816
    s_waitcnt lgkmcnt(2)
    v_mfma_f32_32x32x16_bf16 v[80:95], v[40:43], v[44:47], v[80:95]
    ds_read_b128 v[40:43], v10 offset:35840
    ds_read_b128 v[44:47], v11 offset:35840
    s_waitcnt lgkmcnt(2)
    v_mfma_f32_32x32x16_bf16 v[80:95], v[32:35], v[36:39], v[80:95]
    v_fmac_f32 v64, v96, v117
    v_fmac_f32 v65, v97, v117
    v_fmac_f32 v66, v98, v117
    v_fmac_f32 v67, v99, v117
    s_waitcnt vmcnt(8)
    s_barrier
    ds_read_b128 v[32:35], v14 offset:0
    ds_read_b128 v[36:39], v15 offset:0
    s_waitcnt lgkmcnt(2)
    v_mfma_f32_32x32x16_bf16 v[80:95], v[40:43], v[44:47], v[80:95]
    v_fmac_f32 v68, v100, v117
    v_fmac_f32 v69, v101, v117
    v_fmac_f32 v70, v102, v117
    v_fmac_f32 v71, v103, v117
    ds_read_b128 v[40:43], v14 offset:1024
    ds_read_b128 v[44:47], v15 offset:1024
    s_waitcnt lgkmcnt(2)
    v_mfma_f32_32x32x16_bf16 v[80:95], v[32:35], v[36:39], v[80:95]
    v_fmac_f32 v72, v104, v117
    v_fmac_f32 v73, v105, v117
    v_fmac_f32 v74, v106, v117
    v_fmac_f32 v75, v107, v117
    ds_read_b128 v[32:35], v14 offset:2048
    ds_read_b128 v[36:39], v15 offset:2048
    s_waitcnt lgkmcnt(2)
    v_mfma_f32_32x32x16_bf16 v[80:95], v[40:43], v[44:47], v[80:95]
    v_fmac_f32 v76, v108, v117
    v_fmac_f32 v77, v109, v117
    v_fmac_f32 v78, v110, v117
    v_fmac_f32 v79, v111, v117
    ds_read_b128 v[40:43], v14 offset:3072
    ds_read_b128 v[44:47], v15 offset:3072
    s_waitcnt lgkmcnt(2)
    v_mfma_f32_32x32x16_bf16 v[80:95], v[32:35], v[36:39], v[80:95]
    s_waitcnt vmcnt(4)
    s_barrier
    ds_read_b128 v[32:35], v14 offset:16384
    ds_read_b128 v[36:39], v15 offset:16384
    s_waitcnt lgkmcnt(2)
    v_mfma_f32_32x32x16_bf16 v[80:95], v[40:43], v[44:47], v[80:95]
    ds_read_b128 v[40:43], v14 offset:17408
    ds_read_b128 v[44:47], v15 offset:17408
    s_waitcnt lgkmcnt(2)
    v_mfma_f32_32x32x16_bf16 v[96:111], v[32:35], v[36:39], 0
    ds_read_b128 v[32:35], v14 offset:18432
    ds_read_b128 v[36:39], v15 offset:18432
    s_waitcnt lgkmcnt(2)
    v_mfma_f32_32x32x16_bf16 v[96:111], v[40:43], v[44:47], v[96:111]
    ds_read_b128 v[40:43], v14 offset:19456
    ds_read_b128 v[44:47], v15 offset:19456
    s_waitcnt lgkmcnt(2)
    v_mfma_f32_32x32x16_bf16 v[96:111], v[32:35], v[36:39], v[96:111]
    v_fmac_f32 v64, v80, v118
    v_fmac_f32 v65, v81, v118
    v_fmac_f32 v66, v82, v118
    v_fmac_f32 v67, v83, v118
    s_waitcnt vmcnt(0)
    s_barrier
    ds_read_b128 v[32:35], v14 offset:32768
    ds_read_b128 v[36:39], v15 offset:32768
    s_waitcnt lgkmcnt(2)
    v_mfma_f32_32x32x16_bf16 v[96:111], v[40:43], v[44:47], v[96:111]
    v_fmac_f32 v68, v84, v118
    v_fmac_f32 v69, v85, v118
    v_fmac_f32 v70, v86, v118
    v_fmac_f32 v71, v87, v118
    ds_read_b128 v[40:43], v14 offset:33792
    ds_read_b128 v[44:47], v15 offset:33792
    s_waitcnt lgkmcnt(2)
    v_mfma_f32_32x32x16_bf16 v[96:111], v[32:35], v[36:39], v[96:111]
    v_fmac_f32 v72, v88, v118
    v_fmac_f32 v73, v89, v118
    v_fmac_f32 v74, v90, v118
    v_fmac_f32 v75, v91, v118
    ds_read_b128 v[32:35], v14 offset:34816
    ds_read_b128 v[36:39], v15 offset:34816
    s_waitcnt lgkmcnt(2)
    v_mfma_f32_32x32x16_bf16 v[96:111], v[40:43], v[44:47], v[96:111]
    ds_read_b128 v[48:51], v18
    ds_read_b128 v[52:55], v19
    s_waitcnt lgkmcnt(0)
    v_fmac_f32 v76, v92, v118
    v_fmac_f32 v77, v93, v118
    v_fmac_f32 v78, v94, v118
    v_fmac_f32 v79, v95, v118
    ds_read_b128 v[40:43], v14 offset:35840
    ds_read_b128 v[44:47], v15 offset:35840
    s_waitcnt lgkmcnt(2)
    v_mfma_f32_32x32x16_bf16 v[96:111], v[32:35], v[36:39], v[96:111]
    s_waitcnt lgkmcnt(0)
    v_mfma_f32_32x32x16_bf16 v[96:111], v[40:43], v[44:47], v[96:111]
    s_nop 11
    v_fmac_f32 v64, v96, v119
    v_fmac_f32 v65, v97, v119
    v_fmac_f32 v66, v98, v119
    v_fmac_f32 v67, v99, v119
    v_fmac_f32 v68, v100, v119
    v_fmac_f32 v69, v101, v119
    v_fmac_f32 v70, v102, v119
    v_fmac_f32 v71, v103, v119
    v_fmac_f32 v72, v104, v119
    v_fmac_f32 v73, v105, v119
    v_fmac_f32 v74, v106, v119
    v_fmac_f32 v75, v107, v119
    v_fmac_f32 v76, v108, v119
    v_fmac_f32 v77, v109, v119
    v_fmac_f32 v78, v110, v119
    v_fmac_f32 v79, v111, v119
    v_permlane32_swap_b32 v64, v68
    v_permlane32_swap_b32 v65, v69
    v_permlane32_swap_b32 v66, v70
    v_permlane32_swap_b32 v67, v71
    v_permlane32_swap_b32 v72, v76
    v_permlane32_swap_b32 v73, v77
    v_permlane32_swap_b32 v74, v78
    v_permlane32_swap_b32 v75, v79
    s_waitcnt lgkmcnt(0)
    v_lshlrev_b32 v5, 16, v48
    v_and_b32 v6, 0xffff0000, v48
    v_add_f32 v64, v64, v5
    v_add_f32 v65, v65, v6
    v_cvt_pk_bf16_f32 v48, v64, v65
    v_lshlrev_b32 v5, 16, v49
    v_and_b32 v6, 0xffff0000, v49
    v_add_f32 v66, v66, v5
    v_add_f32 v67, v67, v6
    v_cvt_pk_bf16_f32 v49, v66, v67
    v_lshlrev_b32 v5, 16, v50
    v_and_b32 v6, 0xffff0000, v50
    v_add_f32 v68, v68, v5
    v_add_f32 v69, v69, v6
    v_cvt_pk_bf16_f32 v50, v68, v69
    v_lshlrev_b32 v5, 16, v51
    v_and_b32 v6, 0xffff0000, v51
    v_add_f32 v70, v70, v5
    v_add_f32 v71, v71, v6
    v_cvt_pk_bf16_f32 v51, v70, v71
    ds_write_b128 v18, v[48:51]
    v_lshlrev_b32 v5, 16, v52
    v_and_b32 v6, 0xffff0000, v52
    v_add_f32 v72, v72, v5
    v_add_f32 v73, v73, v6
    v_cvt_pk_bf16_f32 v52, v72, v73
    v_lshlrev_b32 v5, 16, v53
    v_and_b32 v6, 0xffff0000, v53
    v_add_f32 v74, v74, v5
    v_add_f32 v75, v75, v6
    v_cvt_pk_bf16_f32 v53, v74, v75
    v_lshlrev_b32 v5, 16, v54
    v_and_b32 v6, 0xffff0000, v54
    v_add_f32 v76, v76, v5
    v_add_f32 v77, v77, v6
    v_cvt_pk_bf16_f32 v54, v76, v77
    v_lshlrev_b32 v5, 16, v55
    v_and_b32 v6, 0xffff0000, v55
    v_add_f32 v78, v78, v5
    v_add_f32 v79, v79, v6
    v_cvt_pk_bf16_f32 v55, v78, v79
    ds_write_b128 v19, v[52:55]
    s_waitcnt lgkmcnt(0)
    s_barrier
    s_lshl_b32 s23, s20, 11
    s_add_u32 s23, s23, 98304
    v_add_u32 v2, s23, v8
    ds_read_b128 v[48:51], v2
    ds_read_b128 v[52:55], v2 offset:1024
    s_waitcnt lgkmcnt(1)
    buffer_store_dwordx4 v[48:51], v12, s[16:19], 0 offen
    s_waitcnt lgkmcnt(0)
    buffer_store_dwordx4 v[52:55], v13, s[16:19], 0 offen
K3_END:
    s_endpgm
.section .rodata,"a"
.p2align 6
.amdhsa_kernel k1_kernel
  .amdhsa_next_free_vgpr 172
  .amdhsa_next_free_sgpr 102
  .amdhsa_accum_offset 172
  .amdhsa_group_segment_fixed_size 0
  .amdhsa_kernarg_size 96
  .amdhsa_user_sgpr_count 2
  .amdhsa_user_sgpr_kernarg_segment_ptr 1
  .amdhsa_system_sgpr_workgroup_id_x 1
.end_amdhsa_kernel
.amdhsa_kernel k2_kernel
  .amdhsa_next_free_vgpr 256
  .amdhsa_next_free_sgpr 64
  .amdhsa_accum_offset 256
  .amdhsa_group_segment_fixed_size 0
  .amdhsa_kernarg_size 96
  .amdhsa_user_sgpr_count 2
  .amdhsa_user_sgpr_kernarg_segment_ptr 1
  .amdhsa_system_sgpr_workgroup_id_x 1
.end_amdhsa_kernel
.amdhsa_kernel k3_kernel
  .amdhsa_next_free_vgpr 128
  .amdhsa_next_free_sgpr 64
  .amdhsa_accum_offset 128
  .amdhsa_group_segment_fixed_size 0
  .amdhsa_kernarg_size 96
  .amdhsa_user_sgpr_count 2
  .amdhsa_user_sgpr_kernarg_segment_ptr 1
  .amdhsa_system_sgpr_workgroup_id_x 1
.end_amdhsa_kernel
```
